```python
import torch

def _softmax(x, axis=-1):
    return torch.softmax(x, dim=axis)

def _gelu(x):
    return torch.nn.functional.gelu(x, approximate='tanh')

def _silu(x):
    return torch.nn.functional.silu(x)

def _sigmoid(x):
    return torch.sigmoid(x)

def _layernorm(x, axis=-1, eps=1e-05):
    m = x.mean(dim=axis, keepdim=True)
    v = x.var(dim=axis, keepdim=True, unbiased=False)
    return (x - m) / torch.sqrt(v + eps)

def _scatter_add(tgt, idx, src, axis=0):
    return tgt.clone().index_add_(axis, idx, src)

def _segment_sum(src, seg, n):
    out = torch.zeros((n,) + src.shape[1:], dtype=src.dtype)
    return out.index_add_(0, seg, src)

def _pad(x, pw):
    flat = tuple((v for pair in reversed(pw) for v in pair))
    return torch.nn.functional.pad(x, flat)
kernel_name = 'adaLN_cond__spectral_gfnet__glu_gated_reglu__prompt'

def setup_inputs():

    _w = lambda a: (lambda t: t.to(torch.bfloat16) if t.is_floating_point() else t)(torch.as_tensor(a))

    def _A_setup():
        B, S, D = (1, 2048, 448)
        Df = D // 2 + 1
        return {'x': _w((lambda *s: torch.randn(*s, dtype=torch.bfloat16) * 0.05)(B, S, D)), 'w_r': _w((lambda *s: torch.randn(*s, dtype=torch.bfloat16) * 3.2)(S, Df) * 0.02), 'w_i': _w((lambda *s: torch.randn(*s, dtype=torch.bfloat16) * 3.2)(S, Df) * 0.02)}
    _A_in = _A_setup()

    def _B_setup():
        B, S, D, F = (1, 2048, 448, 1792)
        return {'x': _w((lambda *s: torch.randn(*s, dtype=torch.bfloat16) * 0.05)(B, S, D)), 'W_gate': _w((lambda *s: torch.randn(*s, dtype=torch.bfloat16) * 0.4)(D, F) * (2.0 / D) ** 0.5), 'W_up': _w((lambda *s: torch.randn(*s, dtype=torch.bfloat16) * 0.4)(D, F) * (2.0 / D) ** 0.5), 'W_down': _w((lambda *s: torch.randn(*s, dtype=torch.bfloat16) * 0.4)(F, D) * (1.0 / F) ** 0.5)}
    _B_in = _B_setup()
    return {'A_x': _A_in['x'], 'A_w_r': _A_in['w_r'], 'A_w_i': _A_in['w_i'], 'B_x': _B_in['x'], 'B_W_gate': _B_in['W_gate'], 'B_W_up': _B_in['W_up'], 'B_W_down': _B_in['W_down'], 'c': _w((lambda *s: torch.randn(*s, dtype=torch.bfloat16) * 0.1)(1, 448) * 8.0), 'w_mod': _w((lambda *s: torch.randn(*s, dtype=torch.bfloat16) * 0.1)(448, 6 * 448) * 448 ** (-0.5) * 8.0)}

def reference(A_x, A_w_r, A_w_i, B_x, B_W_gate, B_W_up, B_W_down, c, w_mod):

    def _A_ref(x, w_r, w_i):
        B, S, D = x.shape
        X = (lambda x, axes=(-2, -1): torch.fft.rfft2(x.float(), dim=axes))(x, axes=(-2, -1))
        W = w_r + 1j * w_i
        X = X * W
        y = (lambda x, s, axes=(-2, -1): torch.fft.irfft2(x, s=s, dim=axes).to(torch.bfloat16))(X, (S, D), axes=(-2, -1))
        return y

    def _B_ref(x, W_gate, W_up, W_down):
        gate = torch.einsum('bsd,df->bsf', x, W_gate)
        up = torch.einsum('bsd,df->bsf', x, W_up)
        gate = gate * (lambda x, dt: x.to(dt))(gate > 0, gate.dtype)
        h = gate * up
        return torch.einsum('bsf,fd->bsd', h, W_down)
    x = A_x
    mod = (_silu(c) @ w_mod).reshape(c.shape[0], 6, 1, -1)
    sa, ca, ga, sb, cb, gb = (mod[:, 0].clone(), mod[:, 1].clone(), mod[:, 2].clone(), mod[:, 3].clone(), mod[:, 4].clone(), mod[:, 5].clone())
    h = _layernorm(x, axis=-1) * (1 + ca) + sa
    x = x + ga * _A_ref(h, A_w_r, A_w_i)
    h = _layernorm(x, axis=-1) * (1 + cb) + sb
    x = x + gb * _B_ref(h, B_W_gate, B_W_up, B_W_down)
    return x
```

```asm
; @launch kernel=k01_kernel grid=(256,1,1) block=(512,1,1) lds=124928
; @launch kernel=k2_kernel grid=(224,1,1) block=(256,1,1) lds=158208
.amdgcn_target "amdgcn-amd-amdhsa--gfx950"
.text
.globl k01_kernel
.p2align 8
.type k01_kernel,@function
k01_kernel:
    s_load_dwordx2 s[8:9], s[0:1], 0
    s_load_dwordx4 s[76:79], s[0:1], 56
    v_readfirstlane_b32 s3, v0
    s_cmpk_lt_u32 s2, 128
    s_cbranch_scc1 K01_A
    s_cmpk_lt_u32 s2, 176
    s_cbranch_scc1 K01_B
    s_cmpk_lt_u32 s2, 240
    s_cbranch_scc1 K01_F
    s_getpc_b64 s[36:37]
    v_lshlrev_b32 v1, 5, v0
    global_load_dword v252, v1, s[36:37]
    s_branch K01_DX
K01_A:
    s_lshr_b32 s3, s3, 6
    v_and_b32 v0, 63, v0
    v_lshlrev_b32 v1, 4, v0
    s_lshr_b32 s21, s2, 5
    s_and_b32 s20, s2, 7
    s_lshl3_add_u32 s21, s21, s20
    s_lshr_b32 s25, s2, 3
    s_lshl1_add_u32 s25, s25, s3
    s_and_b32 s25, s25, 7
    s_lshl_b32 s23, s25, 8
    s_add_u32 s23, s23, s21
    s_mulk_i32 s23, 896
    s_mul_i32 m0, s25, 7296
    s_mov_b32 s10, 0x1c0000
    s_mov_b32 s11, 0x00020000
    s_waitcnt lgkmcnt(0)
    s_cmp_ge_u32 s3, 4
    s_cbranch_scc1 K01_A0
    s_lshr_b32 exec_hi, exec_hi, 8
    buffer_load_dwordx4 v1, s[8:11], s23 offen offset:0 lds
    s_addk_i32 s23, 27760
    buffer_load_dwordx4 v1, s[8:11], s23 offen offset:912 lds
    s_addk_i32 s23, 27760
    buffer_load_dwordx4 v1, s[8:11], s23 offen offset:1824 lds
    s_addk_i32 s23, 27760
    buffer_load_dwordx4 v1, s[8:11], s23 offen offset:2736 lds
    s_addk_i32 m0, 3648
    s_addk_i32 s23, 31408
    buffer_load_dwordx4 v1, s[8:11], s23 offen offset:0 lds
    s_addk_i32 s23, 27760
    buffer_load_dwordx4 v1, s[8:11], s23 offen offset:912 lds
    s_addk_i32 s23, 27760
    buffer_load_dwordx4 v1, s[8:11], s23 offen offset:1824 lds
    s_addk_i32 s23, 27760
    buffer_load_dwordx4 v1, s[8:11], s23 offen offset:2736 lds
    s_mov_b32 exec_hi, -1
K01_A0:
    s_load_dwordx4 s[68:71], s[0:1], 80
    s_load_dwordx4 s[64:67], s[0:1], 32
    s_load_dwordx2 s[6:7], s[0:1], 48
    v_and_b32 v2, 15, v0
    v_lshrrev_b32 v3, 4, v0
    s_waitcnt lgkmcnt(0)
    s_mov_b32 s12, s70
    s_mov_b32 s13, s71
    s_mov_b32 s14, 0x10000000
    s_mov_b32 s15, 0x00020000
    s_mov_b32 s72, s68
    s_mov_b32 s73, s69
    s_mov_b32 s74, 0x100
    s_mov_b32 s75, 0x00020000
    s_cmp_lg_u32 s3, 7
    s_cbranch_scc1 K01_AQ0
    s_bfe_u32 s30, s2, 0x10003
    s_mul_i32 s30, s30, 896
    s_add_u32 s30, s30, 0xae00
    s_add_u32 s31, s30, 7168
    buffer_load_dword v232, v1, s[12:15], s30 offen offset:0 sc1
    buffer_load_dword v233, v1, s[12:15], s30 offen offset:1792 sc1
    buffer_load_dword v234, v1, s[12:15], s31 offen offset:0 sc1
    buffer_load_dword v235, v1, s[12:15], s31 offen offset:1792 sc1
K01_AQ0:
    s_lshr_b32 s22, s2, 2
    s_and_b32 s22, s22, 6
    s_lshr_b32 s20, s3, 2
    s_add_u32 s22, s22, s20
    s_and_b32 s29, s3, 3
    s_lshl_b32 s24, s29, 4
    v_add_u32 v4, s24, v2
    v_lshrrev_b32 v5, 1, v4
    v_and_b32 v6, 1, v4
    v_cmp_eq_u32 vcc, 1, v4
    v_mov_b32 v7, 32
    s_nop 0
    v_cndmask_b32 v5, v5, v7, vcc
    v_mov_b32 v7, 0
    v_cndmask_b32 v6, v6, v7, vcc
    v_cvt_f32_u32 v5, v5
    v_cvt_f32_u32 v6, v6
    v_mul_f32 v5, 0x3c800000, v5
    v_mul_f32 v6, 0x3e800000, v6
    v_lshlrev_b32 v7, 3, v3
    v_cvt_f32_u32 v7, v7
    v_fma_f32 v6, v5, v7, v6
    v_mul_f32 v7, 0x42000000, v5
    v_add_f32 v7, v7, v6
    v_cos_f32 v80, v6
    v_cos_f32 v88, v7
    v_add_f32 v6, v6, v5
    v_add_f32 v7, v7, v5
    v_cos_f32 v81, v6
    v_cos_f32 v89, v7
    v_add_f32 v6, v6, v5
    v_add_f32 v7, v7, v5
    v_cos_f32 v82, v6
    v_cos_f32 v90, v7
    v_add_f32 v6, v6, v5
    v_add_f32 v7, v7, v5
    v_cos_f32 v83, v6
    v_cos_f32 v91, v7
    v_add_f32 v6, v6, v5
    v_add_f32 v7, v7, v5
    v_cos_f32 v84, v6
    v_cos_f32 v92, v7
    v_add_f32 v6, v6, v5
    v_add_f32 v7, v7, v5
    v_cos_f32 v85, v6
    v_cos_f32 v93, v7
    v_add_f32 v6, v6, v5
    v_add_f32 v7, v7, v5
    v_cos_f32 v86, v6
    v_cos_f32 v94, v7
    v_add_f32 v6, v6, v5
    v_add_f32 v7, v7, v5
    v_cos_f32 v87, v6
    v_cos_f32 v95, v7
    s_lshl_b32 s55, s22, 4
    s_add_u32 s55, s55, s21
    s_mul_i32 s20, s55, 96
    s_add_u32 s20, s20, 32768
    s_lshl_b32 s55, s55, 5
    s_add_u32 s55, s55, 0x1d0000
    v_lshlrev_b32 v182, 14, v0
    v_mov_b32 v185, 0x7fff0000
    v_cmp_gt_u32 vcc, 2, v0
    s_nop 1
    v_cndmask_b32 v182, v185, v182, vcc
    v_writelane_b32 v182, s20, 2
    s_lshl_b32 s24, s25, 3
    v_lshrrev_b32 v4, 3, v0
    v_and_b32 v6, 7, v0
    v_add_u32 v4, s24, v4
    v_mul_u32_u24 v5, 912, v4
    v_lshl_add_u32 v5, v6, 4, v5
    v_and_b32 v6, 3, v0
    v_lshrrev_b32 v7, 2, v2
    v_lshl_add_u32 v7, v3, 3, v7
    v_mul_u32_u24 v8, 912, v7
    v_mul_u32_u24 v7, 224, v6
    s_lshl_b32 s25, s22, 3
    v_add3_u32 v8, v8, v7, s25
    v_mul_u32_u24 v11, 114688, v3
    s_and_b32 s27, s21, 3
    v_xor_b32 v7, s27, v2
    v_lshl_add_u32 v11, v7, 4, v11
    s_mul_i32 s26, s29, 458752
    s_lshl_b32 s27, s21, 8
    s_add_u32 s26, s26, s27
    s_lshl_b32 s27, s22, 13
    s_add_u32 s26, s26, s27
    s_add_u32 s26, s26, 0x10000
    s_add_u32 s27, s26, 57344
    v_lshlrev_b32 v12, 2, v4
    v_lshlrev_b32 v13, 1, v4
    v_lshlrev_b32 v14, 5, v3
    v_lshlrev_b32 v15, 4, v3
    s_mov_b32 s28, 0x3f803f80
    v_mov_b32 v16, 0
    v_mov_b32 v17, 0
    v_mov_b32 v18, 0
    v_mov_b32 v19, 0
    s_cmp_lt_u32 s3, 4
    s_cbranch_scc1 K01_A1
    s_lshr_b32 exec_hi, exec_hi, 8
    buffer_load_dwordx4 v1, s[8:11], s23 offen offset:0 lds
    s_addk_i32 s23, 27760
    buffer_load_dwordx4 v1, s[8:11], s23 offen offset:912 lds
    s_addk_i32 s23, 27760
    buffer_load_dwordx4 v1, s[8:11], s23 offen offset:1824 lds
    s_addk_i32 s23, 27760
    buffer_load_dwordx4 v1, s[8:11], s23 offen offset:2736 lds
    s_addk_i32 m0, 3648
    s_addk_i32 s23, 31408
    buffer_load_dwordx4 v1, s[8:11], s23 offen offset:0 lds
    s_addk_i32 s23, 27760
    buffer_load_dwordx4 v1, s[8:11], s23 offen offset:912 lds
    s_addk_i32 s23, 27760
    buffer_load_dwordx4 v1, s[8:11], s23 offen offset:1824 lds
    s_addk_i32 s23, 27760
    buffer_load_dwordx4 v1, s[8:11], s23 offen offset:2736 lds
    s_mov_b32 exec_hi, -1
    s_waitcnt vmcnt(0)
K01_A1:
    s_waitcnt vmcnt(0)
    ds_read_b128 v[20:23], v5 offset:0
    ds_read_b128 v[24:27], v5 offset:128
    ds_read_b128 v[28:31], v5 offset:256
    ds_read_b128 v[32:35], v5 offset:384
    ds_read_b128 v[36:39], v5 offset:512
    ds_read_b128 v[40:43], v5 offset:640
    ds_read_b128 v[44:47], v5 offset:768
    s_cmp_lg_u32 s3, 0
    s_cbranch_scc1 K01_A6
    buffer_load_dword v184, v182, s[12:15], s55 offen sc1
K01_A6:
    s_waitcnt lgkmcnt(6)
    v_dot2c_f32_bf16 v16, s28, v20
    v_dot2c_f32_bf16 v18, v20, v20
    v_dot2c_f32_bf16 v17, s28, v21
    v_dot2c_f32_bf16 v19, v21, v21
    v_dot2c_f32_bf16 v16, s28, v22
    v_dot2c_f32_bf16 v18, v22, v22
    v_dot2c_f32_bf16 v17, s28, v23
    v_dot2c_f32_bf16 v19, v23, v23
    s_waitcnt lgkmcnt(5)
    v_dot2c_f32_bf16 v16, s28, v24
    v_dot2c_f32_bf16 v18, v24, v24
    v_dot2c_f32_bf16 v17, s28, v25
    v_dot2c_f32_bf16 v19, v25, v25
    v_dot2c_f32_bf16 v16, s28, v26
    v_dot2c_f32_bf16 v18, v26, v26
    v_dot2c_f32_bf16 v17, s28, v27
    v_dot2c_f32_bf16 v19, v27, v27
    s_waitcnt lgkmcnt(4)
    v_dot2c_f32_bf16 v16, s28, v28
    v_dot2c_f32_bf16 v18, v28, v28
    v_dot2c_f32_bf16 v17, s28, v29
    v_dot2c_f32_bf16 v19, v29, v29
    v_dot2c_f32_bf16 v16, s28, v30
    v_dot2c_f32_bf16 v18, v30, v30
    v_dot2c_f32_bf16 v17, s28, v31
    v_dot2c_f32_bf16 v19, v31, v31
    s_waitcnt lgkmcnt(3)
    v_dot2c_f32_bf16 v16, s28, v32
    v_dot2c_f32_bf16 v18, v32, v32
    v_dot2c_f32_bf16 v17, s28, v33
    v_dot2c_f32_bf16 v19, v33, v33
    v_dot2c_f32_bf16 v16, s28, v34
    v_dot2c_f32_bf16 v18, v34, v34
    v_dot2c_f32_bf16 v17, s28, v35
    v_dot2c_f32_bf16 v19, v35, v35
    s_waitcnt lgkmcnt(2)
    v_dot2c_f32_bf16 v16, s28, v36
    v_dot2c_f32_bf16 v18, v36, v36
    v_dot2c_f32_bf16 v17, s28, v37
    v_dot2c_f32_bf16 v19, v37, v37
    v_dot2c_f32_bf16 v16, s28, v38
    v_dot2c_f32_bf16 v18, v38, v38
    v_dot2c_f32_bf16 v17, s28, v39
    v_dot2c_f32_bf16 v19, v39, v39
    s_waitcnt lgkmcnt(1)
    v_dot2c_f32_bf16 v16, s28, v40
    v_dot2c_f32_bf16 v18, v40, v40
    v_dot2c_f32_bf16 v17, s28, v41
    v_dot2c_f32_bf16 v19, v41, v41
    v_dot2c_f32_bf16 v16, s28, v42
    v_dot2c_f32_bf16 v18, v42, v42
    v_dot2c_f32_bf16 v17, s28, v43
    v_dot2c_f32_bf16 v19, v43, v43
    s_waitcnt lgkmcnt(0)
    v_dot2c_f32_bf16 v16, s28, v44
    v_dot2c_f32_bf16 v18, v44, v44
    v_dot2c_f32_bf16 v17, s28, v45
    v_dot2c_f32_bf16 v19, v45, v45
    v_dot2c_f32_bf16 v16, s28, v46
    v_dot2c_f32_bf16 v18, v46, v46
    v_dot2c_f32_bf16 v17, s28, v47
    v_dot2c_f32_bf16 v19, v47, v47
    s_nop 1
    v_add_f32 v16, v16, v17
    v_add_f32 v18, v18, v19
    s_nop 0
    v_add_f32_dpp v16, v16, v16 quad_perm:[1,0,3,2] row_mask:0xf bank_mask:0xf
    v_add_f32_dpp v18, v18, v18 quad_perm:[1,0,3,2] row_mask:0xf bank_mask:0xf
    s_nop 0
    v_add_f32_dpp v16, v16, v16 quad_perm:[2,3,0,1] row_mask:0xf bank_mask:0xf
    v_add_f32_dpp v18, v18, v18 quad_perm:[2,3,0,1] row_mask:0xf bank_mask:0xf
    s_nop 0
    v_add_f32_dpp v16, v16, v16 row_half_mirror row_mask:0xf bank_mask:0xf
    v_add_f32_dpp v18, v18, v18 row_half_mirror row_mask:0xf bank_mask:0xf
    v_mul_f32 v16, 0x3b124925, v16
    v_mul_f32 v18, 0x3b124925, v18
    v_fma_f32 v18, -v16, v16, v18
    v_max_f32 v18, 0, v18
    v_cvt_pk_bf16_f32 v17, -v16, -v16
    v_cvt_pk_bf16_f32 v18, v18, v18
    v_lshlrev_b32 v18, 16, v18
    ds_write_b16 v13, v17 offset:58624
    v_add_f32 v18, 0x3727c5ac, v18
    v_cvt_pk_bf16_f32 v18, v18, v18
    v_lshlrev_b32 v18, 16, v18
    v_sqrt_f32 v18, v18
    s_nop 0
    v_cvt_pk_bf16_f32 v18, v18, v18
    v_lshlrev_b32 v18, 16, v18
    v_rcp_f32 v18, v18
    s_nop 0
    ds_write_b32 v12, v18 offset:58368
    s_waitcnt lgkmcnt(0)
    s_barrier
    s_cmp_eq_u32 s22, 7
    s_cbranch_scc1 K01_A2
    ds_read_b128 v[20:23], v14 offset:58368
    ds_read_b128 v[24:27], v14 offset:58384
    ds_read_b128 v[28:31], v14 offset:58496
    ds_read_b128 v[32:35], v14 offset:58512
    ds_read_b128 v[36:39], v15 offset:58624
    ds_read_b128 v[40:43], v15 offset:58688
    ds_read_b64_tr_b16 v[44:45], v8 offset:0
    ds_read_b64_tr_b16 v[46:47], v8 offset:3648
    ds_read_b64_tr_b16 v[52:53], v8 offset:56
    ds_read_b64_tr_b16 v[54:55], v8 offset:3704
    ds_read_b64_tr_b16 v[60:61], v8 offset:112
    ds_read_b64_tr_b16 v[62:63], v8 offset:3760
    ds_read_b64_tr_b16 v[68:69], v8 offset:168
    ds_read_b64_tr_b16 v[70:71], v8 offset:3816
    s_waitcnt lgkmcnt(10)
    v_pk_mul_f32 v[80:81], v[80:81], v[20:21]
    v_pk_mul_f32 v[82:83], v[82:83], v[22:23]
    v_pk_mul_f32 v[84:85], v[84:85], v[24:25]
    v_pk_mul_f32 v[86:87], v[86:87], v[26:27]
    v_pk_mul_f32 v[88:89], v[88:89], v[28:29]
    v_pk_mul_f32 v[90:91], v[90:91], v[30:31]
    v_pk_mul_f32 v[92:93], v[92:93], v[32:33]
    v_pk_mul_f32 v[94:95], v[94:95], v[34:35]
    ds_read_b64_tr_b16 v[48:49], v8 offset:29184
    ds_read_b64_tr_b16 v[50:51], v8 offset:32832
    ds_read_b64_tr_b16 v[56:57], v8 offset:29240
    ds_read_b64_tr_b16 v[58:59], v8 offset:32888
    ds_read_b64_tr_b16 v[64:65], v8 offset:29296
    ds_read_b64_tr_b16 v[66:67], v8 offset:32944
    ds_read_b64_tr_b16 v[72:73], v8 offset:29352
    ds_read_b64_tr_b16 v[74:75], v8 offset:33000
    v_cvt_pk_bf16_f32 v20, v80, v81
    v_cvt_pk_bf16_f32 v21, v82, v83
    v_cvt_pk_bf16_f32 v22, v84, v85
    v_cvt_pk_bf16_f32 v23, v86, v87
    v_cvt_pk_bf16_f32 v24, v88, v89
    v_cvt_pk_bf16_f32 v25, v90, v91
    v_cvt_pk_bf16_f32 v26, v92, v93
    v_cvt_pk_bf16_f32 v27, v94, v95
    s_waitcnt lgkmcnt(8)
    v_mfma_f32_16x16x32_bf16 v[28:31], v[20:23], v[36:39], 0
    v_mfma_f32_16x16x32_bf16 v[28:31], v[24:27], v[40:43], v[28:31]
    v_mfma_f32_16x16x32_bf16 v[80:83], v[20:23], v[44:47], v[28:31]
    v_mfma_f32_16x16x32_bf16 v[84:87], v[20:23], v[52:55], v[28:31]
    v_mfma_f32_16x16x32_bf16 v[88:91], v[20:23], v[60:63], v[28:31]
    v_mfma_f32_16x16x32_bf16 v[92:95], v[20:23], v[68:71], v[28:31]
    s_waitcnt lgkmcnt(0)
    v_mfma_f32_16x16x32_bf16 v[80:83], v[24:27], v[48:51], v[80:83]
    v_mfma_f32_16x16x32_bf16 v[84:87], v[24:27], v[56:59], v[84:87]
    v_mfma_f32_16x16x32_bf16 v[88:91], v[24:27], v[64:67], v[88:91]
    v_mfma_f32_16x16x32_bf16 v[92:95], v[24:27], v[72:75], v[92:95]
    s_nop 5
    v_cvt_pk_bf16_f32 v104, v80, v84
    s_nop 0
    v_cvt_pk_bf16_f32 v105, v88, v92
    v_cvt_pk_bf16_f32 v106, v81, v85
    v_cvt_pk_bf16_f32 v107, v89, v93
    v_cvt_pk_bf16_f32 v108, v82, v86
    v_cvt_pk_bf16_f32 v109, v90, v94
    v_cvt_pk_bf16_f32 v110, v83, v87
    v_cvt_pk_bf16_f32 v111, v91, v95
    buffer_store_dwordx4 v[104:107], v11, s[12:15], s26 offen sc1
    buffer_store_dwordx4 v[108:111], v11, s[12:15], s27 offen sc1
K01_A2:
    s_and_b32 s42, s2, 7
    s_mul_i32 s42, s42, 14
    s_lshr_b32 s41, s2, 3
    s_add_u32 s42, s42, s41
    s_cmp_ge_u32 s42, 56
    s_cselect_b32 s40, 1, 0
    s_cselect_b32 s8, s66, s64
    s_cselect_b32 s9, s67, s65
    s_mul_i32 s41, s40, 56
    s_sub_u32 s42, s42, s41
    s_cmp_lt_u32 s2, 112
    s_cselect_b32 s10, 0x188000, 0
    s_cmp_lt_u32 s3, 7
    s_cselect_b32 s10, s10, 0
    s_and_b32 s41, s42, 1
    s_lshr_b32 s42, s42, 1
    s_mul_i32 s43, s42, 116
    s_add_u32 s43, s43, s40
    s_lshl_b32 s43, s43, 10
    s_add_u32 s43, s43, 0x600000
    v_lshrrev_b32 v4, 3, v0
    v_mul_u32_u24 v5, 3584, v4
    v_and_b32 v6, 7, v0
    v_lshl_add_u32 v176, v6, 4, v5
    s_mul_i32 s44, s41, 7
    s_add_u32 s44, s44, s3
    s_mul_i32 s44, s44, 114688
    s_lshl_b32 s45, s42, 7
    s_add_u32 s44, s44, s45
    s_lshl_b32 s45, s3, 12
    s_add_u32 s45, s45, 61440
    s_and_b32 s46, s3, 1
    s_mul_i32 s46, s46, 56
    s_lshr_b32 s47, s3, 1
    s_lshl_b32 s47, s47, 3
    s_add_u32 s46, s46, s47
    s_cmp_eq_u32 s3, 6
    s_cselect_b32 s47, 56, 28
    s_cselect_b32 s48, 28, 4
    v_lshrrev_b32 v7, 5, v0
    v_mul_u32_u24 v9, s47, v7
    v_add_u32 v9, s46, v9
    v_lshrrev_b32 v5, 2, v2
    v_add_u32 v10, v9, v5
    v_lshlrev_b32 v10, 7, v10
    v_and_b32 v5, 1, v3
    v_lshl_add_u32 v10, v5, 5, v10
    v_and_b32 v5, 3, v0
    v_lshl_add_u32 v177, v5, 3, v10
    s_lshl_b32 s49, s48, 7
    v_add_u32 v178, s49, v177
    s_mul_i32 s49, s41, 896
    s_add_u32 s49, s49, 90112
    v_lshl_add_u32 v179, v9, 2, s49
    s_lshl_b32 s49, s48, 2
    v_add_u32 v180, s49, v179
    s_mul_i32 s50, s41, 14
    s_add_u32 s50, s50, s3
    s_lshl_b32 s50, s50, 11
    s_add_u32 s50, s50, s43
    s_add_u32 s51, s50, 59392
    s_add_u32 s52, s50, 14336
    s_add_u32 s53, s50, 73728
    v_mul_u32_u24 v181, 912, v2
    v_mul_u32_u24 v5, 56, v3
    s_lshr_b32 s46, s22, 1
    s_mul_i32 s47, s46, 224
    s_lshl_b32 s48, s3, 3
    s_add_u32 s47, s47, s48
    v_add3_u32 v181, v181, v5, s47
    s_and_b32 s54, s21, 15
    s_lshl_b32 s54, s54, 2
    s_add_u32 s54, s54, s46
    s_mul_i32 s54, s54, 7
    s_add_u32 s54, s54, s3
    s_lshl_b32 s54, s54, 2
    s_lshr_b32 s46, s21, 4
    s_add_u32 s54, s54, s46
    s_lshl_b32 s54, s54, 10
    s_add_u32 s54, s54, 0x200000
    s_mov_b32 m0, s45
    ds_read_b64 v[188:189], v181 offset:0
    ds_read_b64 v[190:191], v181 offset:29184
    ds_read_b64 v[192:193], v181 offset:14592
    ds_read_b64 v[194:195], v181 offset:43776
    v_mov_b32 v12, 0x3f803f80
    v_mov_b32 v13, 0x3f803f80
    v_mov_b32 v14, 0x3f803f80
    v_mov_b32 v15, 0x3f803f80
    s_cmp_lg_u32 s3, 0
    s_waitcnt vmcnt(0)
    s_cbranch_scc1 K01_A3
    v_add_u32 v184, 1, v184
    s_barrier
    buffer_store_dword v184, v182, s[12:15], s55 offen sc1
    s_branch K01_A4
K01_A3:
    s_barrier
K01_A4:
    buffer_load_dwordx4 v176, s[8:11], s44 offen nt lds
    s_add_u32 m0, m0, 1024
    s_add_u32 s44, s44, 28672
    buffer_load_dwordx4 v176, s[8:11], s44 offen nt lds
    s_add_u32 m0, m0, 1024
    s_add_u32 s44, s44, 28672
    buffer_load_dwordx4 v176, s[8:11], s44 offen nt lds
    s_add_u32 m0, m0, 1024
    s_add_u32 s44, s44, 28672
    buffer_load_dwordx4 v176, s[8:11], s44 offen nt lds
    s_cmp_eq_u32 s3, 7
    s_cbranch_scc1 K01_AF
    s_cmp_eq_u32 s3, 7
    s_cbranch_scc1 K01_AF
    s_cmp_ge_u32 s2, 120
    s_cbranch_scc1 K01_AW
    v_cmp_gt_u32 vcc, 32, v0
    s_waitcnt vmcnt(0)
    s_barrier
    s_cmp_ge_u32 s2, 112
    s_cbranch_scc1 K01_A5
    ds_read_b128 v[32:35], v179 offset:1792
    ds_read_b128 v[36:39], v180 offset:1792
    ds_read_b64_tr_b16 v[64:65], v177 offset:61440
    ds_read_b64_tr_b16 v[66:67], v178 offset:61440
    ds_read_b64_tr_b16 v[68:69], v177 offset:61504
    ds_read_b64_tr_b16 v[70:71], v178 offset:61504
    v_add_u32 v10, 14336, v177
    v_add_u32 v11, 14336, v178
    ds_read_b128 v[40:43], v179 offset:2240
    ds_read_b128 v[44:47], v180 offset:2240
    ds_read_b64_tr_b16 v[72:73], v10 offset:61440
    ds_read_b64_tr_b16 v[74:75], v11 offset:61440
    ds_read_b64_tr_b16 v[76:77], v10 offset:61504
    ds_read_b64_tr_b16 v[78:79], v11 offset:61504
    ds_read_b128 v[48:51], v179 offset:0
    ds_read_b128 v[52:55], v180 offset:0
    ds_read_b128 v[56:59], v179 offset:448
    ds_read_b128 v[60:63], v180 offset:448
    s_waitcnt lgkmcnt(12)
    v_lshlrev_b32 v160, 16, v64
    v_and_b32 v161, 0xffff0000, v64
    v_pk_mul_f32 v[160:161], v[160:161], v[32:33]
    v_cvt_pk_bf16_f32 v80, v160, v161
    v_lshlrev_b32 v162, 16, v65
    v_and_b32 v163, 0xffff0000, v65
    v_pk_mul_f32 v[162:163], v[162:163], v[34:35]
    v_cvt_pk_bf16_f32 v81, v162, v163
    v_lshlrev_b32 v164, 16, v66
    v_and_b32 v165, 0xffff0000, v66
    v_pk_mul_f32 v[164:165], v[164:165], v[36:37]
    v_cvt_pk_bf16_f32 v82, v164, v165
    v_lshlrev_b32 v166, 16, v67
    v_and_b32 v167, 0xffff0000, v67
    v_pk_mul_f32 v[166:167], v[166:167], v[38:39]
    v_cvt_pk_bf16_f32 v83, v166, v167
    buffer_store_dwordx4 v[80:83], v1, s[12:15], s50 offen sc1
    s_nop 0
    v_mfma_f32_32x32x16_bf16 v[128:143], v[12:15], v[80:83], 0
    s_waitcnt lgkmcnt(10)
    v_lshlrev_b32 v160, 16, v68
    v_and_b32 v161, 0xffff0000, v68
    v_pk_mul_f32 v[160:161], v[160:161], v[32:33]
    v_cvt_pk_bf16_f32 v84, v160, v161
    v_lshlrev_b32 v162, 16, v69
    v_and_b32 v163, 0xffff0000, v69
    v_pk_mul_f32 v[162:163], v[162:163], v[34:35]
    v_cvt_pk_bf16_f32 v85, v162, v163
    v_lshlrev_b32 v164, 16, v70
    v_and_b32 v165, 0xffff0000, v70
    v_pk_mul_f32 v[164:165], v[164:165], v[36:37]
    v_cvt_pk_bf16_f32 v86, v164, v165
    v_lshlrev_b32 v166, 16, v71
    v_and_b32 v167, 0xffff0000, v71
    v_pk_mul_f32 v[166:167], v[166:167], v[38:39]
    v_cvt_pk_bf16_f32 v87, v166, v167
    buffer_store_dwordx4 v[84:87], v1, s[12:15], s51 offen sc1
    s_nop 0
    v_mfma_f32_32x32x16_bf16 v[144:159], v[12:15], v[84:87], 0
    s_waitcnt lgkmcnt(6)
    v_lshlrev_b32 v160, 16, v72
    v_and_b32 v161, 0xffff0000, v72
    v_pk_mul_f32 v[160:161], v[160:161], v[40:41]
    v_cvt_pk_bf16_f32 v88, v160, v161
    v_lshlrev_b32 v162, 16, v73
    v_and_b32 v163, 0xffff0000, v73
    v_pk_mul_f32 v[162:163], v[162:163], v[42:43]
    v_cvt_pk_bf16_f32 v89, v162, v163
    v_lshlrev_b32 v164, 16, v74
    v_and_b32 v165, 0xffff0000, v74
    v_pk_mul_f32 v[164:165], v[164:165], v[44:45]
    v_cvt_pk_bf16_f32 v90, v164, v165
    v_lshlrev_b32 v166, 16, v75
    v_and_b32 v167, 0xffff0000, v75
    v_pk_mul_f32 v[166:167], v[166:167], v[46:47]
    v_cvt_pk_bf16_f32 v91, v166, v167
    buffer_store_dwordx4 v[88:91], v1, s[12:15], s52 offen sc1
    s_nop 0
    v_mfma_f32_32x32x16_bf16 v[128:143], v[12:15], v[88:91], v[128:143]
    s_waitcnt lgkmcnt(4)
    v_lshlrev_b32 v160, 16, v76
    v_and_b32 v161, 0xffff0000, v76
    v_pk_mul_f32 v[160:161], v[160:161], v[40:41]
    v_cvt_pk_bf16_f32 v92, v160, v161
    v_lshlrev_b32 v162, 16, v77
    v_and_b32 v163, 0xffff0000, v77
    v_pk_mul_f32 v[162:163], v[162:163], v[42:43]
    v_cvt_pk_bf16_f32 v93, v162, v163
    v_lshlrev_b32 v164, 16, v78
    v_and_b32 v165, 0xffff0000, v78
    v_pk_mul_f32 v[164:165], v[164:165], v[44:45]
    v_cvt_pk_bf16_f32 v94, v164, v165
    v_lshlrev_b32 v166, 16, v79
    v_and_b32 v167, 0xffff0000, v79
    v_pk_mul_f32 v[166:167], v[166:167], v[46:47]
    v_cvt_pk_bf16_f32 v95, v166, v167
    buffer_store_dwordx4 v[92:95], v1, s[12:15], s53 offen sc1
    s_nop 0
    v_mfma_f32_32x32x16_bf16 v[144:159], v[12:15], v[92:95], v[144:159]
    s_waitcnt lgkmcnt(0)
    v_cvt_pk_bf16_f32 v16, v48, v49
    v_cvt_pk_bf16_f32 v17, v50, v51
    v_cvt_pk_bf16_f32 v18, v52, v53
    v_cvt_pk_bf16_f32 v19, v54, v55
    v_cvt_pk_bf16_f32 v20, v56, v57
    v_cvt_pk_bf16_f32 v21, v58, v59
    v_cvt_pk_bf16_f32 v22, v60, v61
    v_cvt_pk_bf16_f32 v23, v62, v63
    v_mfma_f32_32x32x16_bf16 v[96:111], v[16:19], v[64:67], 0
    v_mfma_f32_32x32x16_bf16 v[112:127], v[16:19], v[68:71], 0
    v_mfma_f32_32x32x16_bf16 v[96:111], v[20:23], v[72:75], v[96:111]
    v_mfma_f32_32x32x16_bf16 v[112:127], v[20:23], v[76:79], v[112:127]
    s_lshl_b32 s24, s3, 9
    s_add_u32 s24, s24, 94208
    v_lshl_add_u32 v11, v0, 3, s24
    v_cndmask_b32 v12, v144, v128, vcc
    s_nop 7
    v_cndmask_b32 v13, v112, v96, vcc
    ds_write_b64 v11, v[12:13]
    s_waitcnt lgkmcnt(0)
    s_barrier
K01_A5:
    s_waitcnt lgkmcnt(0)
    buffer_store_dwordx4 v[188:191], v1, s[12:15], s54 offen offset:0 sc1
    buffer_store_dwordx4 v[192:195], v1, s[12:15], s54 offen offset:2048 sc1
    s_endpgm
K01_AF:
    v_add_u32 v10, 90112, v1
    s_mov_b32 s23, 0xae00
    s_mov_b32 s24, 0xca00
    v_lshlrev_b32 v11, 3, v0
    v_add_u32 v11, 94208, v11
    v_and_b32 v12, 31, v0
    v_lshlrev_b32 v12, 4, v12
    v_lshrrev_b32 v7, 5, v0
    v_mul_u32_u24 v13, 59392, v7
    v_add_u32 v12, v12, v13
    s_lshl_b32 s41, s41, 9
    s_add_u32 s43, s43, s41
    s_add_u32 s43, s43, 57344
    v_mov_b32 v31, 0
    s_mov_b32 s10, 0x188000
    s_mul_i32 s46, s41, 1568
    s_lshl_b32 s47, s42, 7
    s_add_u32 s46, s46, s47
    v_mov_b32 v15, s46
    buffer_load_dword v15, v15, s[8:11], 0 offen
    s_waitcnt vmcnt(0)
    s_cmp_ge_u32 s2, 112
    s_cbranch_scc1 K01_AQ5
    s_sub_u32 s23, s30, 0xae00
    v_add_u32 v10, s23, v10
    s_mov_b32 s90, 0
    s_mov_b32 exec_lo, -1
    s_mov_b32 exec_hi, 0x00ffffff
K01_AQ3:
    buffer_load_dwordx4 v[32:35], v1, s[12:15], s30 offen offset:0 sc1
    buffer_load_dwordx4 v[36:39], v1, s[12:15], s30 offen offset:1792 sc1
    buffer_load_dwordx4 v[40:43], v1, s[12:15], s31 offen offset:0 sc1
    buffer_load_dwordx4 v[44:47], v1, s[12:15], s31 offen offset:1792 sc1
    s_add_u32 s90, s90, 1
    s_cmp_gt_u32 s90, 10
    s_cbranch_scc1 K01_AQS
    s_waitcnt vmcnt(0)
    v_xor_b32 v64, v232, v32
    v_xor_b32 v65, v233, v36
    v_xor_b32 v66, v234, v40
    v_xor_b32 v67, v235, v44
    v_and_b32 v64, v64, v65
    v_and_b32 v66, v66, v67
    v_and_b32 v64, v64, v66
    v_and_b32 v64, 1, v64
    v_cmp_ne_u32 vcc, 1, v64
    s_nop 1
    s_cbranch_vccnz K01_AQ3
K01_AQ4:
    v_and_b32 v32, -2, v32
    v_and_b32 v36, -2, v36
    v_and_b32 v40, -2, v40
    v_and_b32 v44, -2, v44
    v_pk_add_f32 v[32:33], v[32:33], v[40:41]
    v_pk_add_f32 v[34:35], v[34:35], v[42:43]
    v_pk_add_f32 v[36:37], v[36:37], v[44:45]
    v_pk_add_f32 v[38:39], v[38:39], v[46:47]
    v_cvt_pk_bf16_f32 v40, v32, v33
    v_cvt_pk_bf16_f32 v41, v34, v35
    v_cvt_pk_bf16_f32 v42, v36, v37
    v_cvt_pk_bf16_f32 v43, v38, v39
    v_lshlrev_b32 v32, 16, v40
    v_and_b32 v33, 0xffff0000, v40
    v_lshlrev_b32 v34, 16, v41
    v_and_b32 v35, 0xffff0000, v41
    v_lshlrev_b32 v36, 16, v42
    v_and_b32 v37, 0xffff0000, v42
    v_lshlrev_b32 v38, 16, v43
    v_and_b32 v39, 0xffff0000, v43
    v_add_f32 v36, 1.0, v36
    v_add_f32 v37, 1.0, v37
    v_add_f32 v38, 1.0, v38
    v_add_f32 v39, 1.0, v39
    v_cvt_pk_bf16_f32 v40, v36, v37
    v_cvt_pk_bf16_f32 v41, v38, v39
    v_lshlrev_b32 v36, 16, v40
    v_and_b32 v37, 0xffff0000, v40
    v_lshlrev_b32 v38, 16, v41
    v_and_b32 v39, 0xffff0000, v41
    ds_write_b128 v10, v[32:35] offset:0
    ds_write_b128 v10, v[36:39] offset:1792
    s_mov_b64 exec, -1
    s_waitcnt lgkmcnt(0)
    s_barrier
K01_AQ5:
    s_mov_b32 s90, 0
K01_PC1_L:
    buffer_load_dword v68, off, s[72:75], 0 sc1
    s_add_u32 s90, s90, 1
    s_cmp_gt_u32 s90, 200000
    s_cbranch_scc1 K01_PC1_E
    s_waitcnt vmcnt(0)
    v_cmp_ne_u32 vcc, 1, v68
    s_nop 1
    s_cbranch_vccnz K01_PC1_L
K01_PC1_E:
    s_lshl_b32 s88, s2, 7
    s_add_u32 s88, s88, 0x1f0000
    v_mov_b32 v69, 0x7fff0000
    v_writelane_b32 v69, 0, 0
    buffer_store_dword v68, v69, s[12:15], s88 offen sc1
    s_cmp_lt_u32 s2, 112
    s_cbranch_scc1 K01_AQ6
    s_barrier
K01_AQ6:
    s_cmp_ge_u32 s2, 112
    s_cbranch_scc1 K01_END
    s_barrier
    ds_read_b64 v[16:17], v11 offset:0
    ds_read_b64 v[18:19], v11 offset:512
    ds_read_b64 v[20:21], v11 offset:1024
    ds_read_b64 v[22:23], v11 offset:1536
    ds_read_b64 v[24:25], v11 offset:2048
    ds_read_b64 v[26:27], v11 offset:2560
    ds_read_b64 v[28:29], v11 offset:3072
    s_waitcnt lgkmcnt(0)
    v_pk_add_f32 v[16:17], v[16:17], v[18:19]
    v_pk_add_f32 v[20:21], v[20:21], v[22:23]
    v_pk_add_f32 v[24:25], v[24:25], v[26:27]
    v_pk_add_f32 v[16:17], v[16:17], v[20:21]
    v_pk_add_f32 v[24:25], v[24:25], v[28:29]
    v_pk_add_f32 v[16:17], v[16:17], v[24:25]
    v_cvt_pk_bf16_f32 v20, v16, v17
    v_lshlrev_b32 v22, 16, v20
    v_and_b32 v23, 0xffff0000, v20
    v_pk_add_f32 v[16:17], v[16:17], v[22:23] neg_lo:[0,1] neg_hi:[0,1]
    v_cvt_pk_bf16_f32 v21, v16, v17
    v_lshlrev_b32 v24, 16, v21
    v_and_b32 v25, 0xffff0000, v21
    v_pk_add_f32 v[16:17], v[16:17], v[24:25] neg_lo:[0,1] neg_hi:[0,1]
    v_cvt_pk_bf16_f32 v28, v22, v24
    v_cvt_pk_bf16_f32 v29, v16, v23
    v_cvt_pk_bf16_f32 v30, v25, v17
    buffer_store_dwordx4 v[28:31], v12, s[12:15], s43 offen sc1
    s_endpgm
.p2align 7
K01_B:
    s_load_dwordx4 s[68:71], s[0:1], 80
    s_load_dwordx4 s[32:35], s[0:1], 8
    s_load_dwordx2 s[6:7], s[0:1], 48
    s_lshr_b32 s3, s3, 6
    v_and_b32 v0, 63, v0
    v_lshlrev_b32 v1, 4, v0
    v_and_b32 v2, 15, v0
    v_lshrrev_b32 v3, 4, v0
    s_cmp_ge_u32 s2, 170
    s_cbranch_scc1 K01_D
    s_sub_u32 s20, s2, 128
    s_and_b32 s21, s20, 1
    s_mul_i32 s22, s21, 7
    s_lshr_b32 s23, s20, 1
    s_add_u32 s23, s23, 7
    s_sub_u32 s24, s20, 28
    s_cmp_lt_u32 s20, 35
    s_cselect_b32 s24, s24, s20
    s_cmp_lt_u32 s20, 28
    s_cselect_b32 s22, s22, 0
    s_cselect_b32 s23, s23, s24
    s_mov_b32 s26, 1075200
    s_cselect_b32 s26, 0xfffe0f00, s26
    s_cselect_b32 s27, 0, 448
    s_cmp_eq_u32 s3, 7
    s_cbranch_scc1 K01_BR
    s_add_u32 s22, s22, s3
    s_mul_i32 s25, s22, 172032
    s_lshl_b32 s24, s23, 7
    s_add_u32 s25, s25, s24
    s_lshl_b32 s22, s22, 6
    s_lshl_b32 s24, s3, 13
    s_mov_b32 m0, s24
    v_lshrrev_b32 v4, 3, v0
    v_lshlrev_b32 v5, 1, v3
    v_and_b32 v6, 7, v0
    v_xor_b32 v6, v6, v5
    v_mul_u32_u24 v5, 5376, v4
    v_lshl_add_u32 v5, v6, 4, v5
    v_and_b32 v7, 1, v3
    v_mul_u32_u24 v7, s27, v7
    v_lshl_add_u32 v7, v2, 2, v7
    s_waitcnt lgkmcnt(0)
    s_mov_b32 s28, s76
    s_mov_b32 s29, s77
    s_mov_b32 s30, 0x380
    s_mov_b32 s31, 0x00020000
    s_mov_b32 s8, s78
    s_mov_b32 s9, s79
    s_mov_b32 s10, 0x24c000
    s_mov_b32 s11, 0x00020000
    buffer_load_dword v8, v7, s[28:31], s22 offen
    buffer_load_dwordx4 v5, s[8:11], s25 offen nt lds
    s_add_u32 m0, m0, 1024
    s_add_u32 s25, s25, 43008
    buffer_load_dwordx4 v5, s[8:11], s25 offen nt lds
    s_add_u32 m0, m0, 1024
    s_add_u32 s25, s25, 43008
    buffer_load_dwordx4 v5, s[8:11], s25 offen nt lds
    s_add_u32 m0, m0, 1024
    s_add_u32 s25, s25, 43008
    buffer_load_dwordx4 v5, s[8:11], s25 offen nt lds
    s_add_u32 m0, m0, 1024
    s_add_u32 s25, s25, s26
    v_lshrrev_b32 v16, 2, v0
    v_and_b32 v17, 3, v4
    v_lshlrev_b32 v16, 7, v16
    v_lshl_add_u32 v16, v17, 5, v16
    v_and_b32 v17, 3, v0
    v_lshl_add_u32 v16, v17, 3, v16
    v_add_u32 v16, s24, v16
    v_xor_b32 v17, 32, v16
    v_xor_b32 v18, 64, v16
    v_xor_b32 v19, 96, v16
    s_lshl_b32 s24, s3, 8
    v_lshl_add_u32 v20, v3, 4, s24
    v_lshl_add_u32 v21, v0, 2, s24
    v_lshl_add_u32 v22, v3, 3, s24
    s_waitcnt vmcnt(4)
    v_lshlrev_b32 v9, 16, v8
    v_and_b32 v8, 0xffff0000, v8
    v_mul_f32 v10, 0xbfb8aa3b, v8
    v_mul_f32 v11, 0xbfb8aa3b, v9
    v_exp_f32 v10, v10
    v_exp_f32 v11, v11
    v_add_f32 v10, 1.0, v10
    v_add_f32 v11, 1.0, v11
    v_rcp_f32 v10, v10
    v_rcp_f32 v11, v11
    v_mul_f32 v8, v8, v10
    v_mul_f32 v9, v9, v11
    v_cvt_pk_bf16_f32 v9, v9, v8
    ds_write_b32 v21, v9 offset:59392
    ds_read_b64 v[8:9], v22 offset:59392
    ds_read_b64 v[10:11], v22 offset:59424
    ds_read_b64 v[12:13], v22 offset:59456
    ds_read_b64 v[14:15], v22 offset:59488
    buffer_load_dwordx4 v5, s[8:11], s25 offen nt lds
    s_add_u32 m0, m0, 1024
    s_add_u32 s25, s25, 43008
    buffer_load_dwordx4 v5, s[8:11], s25 offen nt lds
    s_add_u32 m0, m0, 1024
    s_add_u32 s25, s25, 43008
    buffer_load_dwordx4 v5, s[8:11], s25 offen nt lds
    s_add_u32 m0, m0, 1024
    s_add_u32 s25, s25, 43008
    buffer_load_dwordx4 v5, s[8:11], s25 offen nt lds
    s_waitcnt vmcnt(4)
    ds_read_b64_tr_b16 v[40:41], v16 offset:0
    ds_read_b64_tr_b16 v[42:43], v16 offset:2048
    ds_read_b64_tr_b16 v[44:45], v17 offset:0
    ds_read_b64_tr_b16 v[46:47], v17 offset:2048
    ds_read_b64_tr_b16 v[48:49], v18 offset:0
    ds_read_b64_tr_b16 v[50:51], v18 offset:2048
    ds_read_b64_tr_b16 v[52:53], v19 offset:0
    ds_read_b64_tr_b16 v[54:55], v19 offset:2048
    s_waitcnt lgkmcnt(6)
    v_mfma_f32_16x16x32_bf16 v[56:59], v[40:43], v[8:11], 0
    s_waitcnt lgkmcnt(4)
    v_mfma_f32_16x16x32_bf16 v[60:63], v[44:47], v[8:11], 0
    s_waitcnt lgkmcnt(2)
    v_mfma_f32_16x16x32_bf16 v[64:67], v[48:51], v[8:11], 0
    s_waitcnt lgkmcnt(0)
    v_mfma_f32_16x16x32_bf16 v[68:71], v[52:55], v[8:11], 0
    s_mov_b32 exec_lo, 0x00010001
    s_mov_b32 exec_hi, 0x00010001
    ds_write_b128 v20, v[56:59] offset:61440
    s_nop 0
    ds_write_b128 v20, v[60:63] offset:61504
    s_nop 0
    ds_write_b128 v20, v[64:67] offset:61568
    s_nop 0
    ds_write_b128 v20, v[68:71] offset:61632
    s_mov_b64 exec, -1
    s_waitcnt lgkmcnt(0)
    s_barrier
    s_waitcnt vmcnt(0)
    ds_read_b64_tr_b16 v[40:41], v16 offset:4096
    ds_read_b64_tr_b16 v[42:43], v16 offset:6144
    ds_read_b64_tr_b16 v[44:45], v17 offset:4096
    ds_read_b64_tr_b16 v[46:47], v17 offset:6144
    ds_read_b64_tr_b16 v[48:49], v18 offset:4096
    ds_read_b64_tr_b16 v[50:51], v18 offset:6144
    ds_read_b64_tr_b16 v[52:53], v19 offset:4096
    ds_read_b64_tr_b16 v[54:55], v19 offset:6144
    s_waitcnt lgkmcnt(6)
    v_mfma_f32_16x16x32_bf16 v[56:59], v[40:43], v[12:15], 0
    s_waitcnt lgkmcnt(4)
    v_mfma_f32_16x16x32_bf16 v[60:63], v[44:47], v[12:15], 0
    s_waitcnt lgkmcnt(2)
    v_mfma_f32_16x16x32_bf16 v[64:67], v[48:51], v[12:15], 0
    s_waitcnt lgkmcnt(0)
    v_mfma_f32_16x16x32_bf16 v[68:71], v[52:55], v[12:15], 0
    s_mov_b32 exec_lo, 0x00010001
    s_mov_b32 exec_hi, 0x00010001
    ds_write_b128 v20, v[56:59] offset:63488
    s_nop 0
    ds_write_b128 v20, v[60:63] offset:63552
    s_nop 0
    ds_write_b128 v20, v[64:67] offset:63616
    s_nop 0
    ds_write_b128 v20, v[68:71] offset:63680
    s_mov_b64 exec, -1
    s_waitcnt lgkmcnt(0)
    s_barrier
    s_lshr_b32 s20, s20, 3
    s_mul_i32 s20, s20, 7
    s_add_u32 s20, s20, s3
    s_lshl_b32 s20, s20, 11
    s_add_u32 s20, s20, 16384
    s_getpc_b64 s[36:37]
K01_PCB:
    s_sub_u32 s36, s36, K01_PCB-k01_kernel
    s_subb_u32 s37, s37, 0
    s_mov_b32 s39, 0x00020000
    s_mov_b32 s38, CODE_END-k01_kernel
    v_add_u32 v24, s20, v1
    buffer_load_dwordx4 v[28:31], v24, s[36:39], 0 offen offset:0
    buffer_load_dwordx4 v[28:31], v24, s[36:39], 0 offen offset:1024
    s_endpgm
K01_BR:
    s_mul_i32 s21, s21, 7168
    s_lshl_b32 s23, s23, 8
    s_add_u32 s21, s21, s23
    s_add_u32 s21, s21, 0x9900
    s_add_u32 s24, s23, 0xd800
    s_cmp_lt_u32 s20, 35
    s_cselect_b32 s23, s24, s23
    s_cselect_b32 s25, 0x45000000, 1.0
    s_waitcnt lgkmcnt(0)
    s_mov_b32 s12, s70
    s_mov_b32 s13, s71
    s_mov_b32 s14, 0x10000000
    s_mov_b32 s15, 0x00020000
    s_mov_b32 s72, s68
    s_mov_b32 s73, s69
    s_mov_b32 s74, 0x100
    s_mov_b32 s75, 0x00020000
    s_mov_b64 exec, 0xffff
    s_cmp_lt_u32 s20, 35
    s_cselect_b32 s26, 1, 0
    buffer_load_dwordx4 v[72:75], v1, s[12:15], s23 offen sc1
    buffer_load_dword v4, v1, s[12:15], s21 offen sc1
    buffer_load_dword v5, v1, s[12:15], s21 offen offset:3584 sc1
    s_waitcnt vmcnt(0)
    v_not_b32 v4, v4
    v_not_b32 v72, v72
    v_not_b32 v73, v73
    v_not_b32 v74, v74
    v_not_b32 v75, v75
    v_not_b32 v5, v5
    s_barrier
    ds_read_b128 v[8:11], v1 offset:61440
    ds_read_b128 v[12:15], v1 offset:61696
    ds_read_b128 v[16:19], v1 offset:61952
    ds_read_b128 v[20:23], v1 offset:62208
    ds_read_b128 v[24:27], v1 offset:62464
    ds_read_b128 v[28:31], v1 offset:62720
    ds_read_b128 v[32:35], v1 offset:62976
    s_waitcnt lgkmcnt(5)
    v_pk_add_f32 v[8:9], v[8:9], v[12:13]
    v_pk_add_f32 v[10:11], v[10:11], v[14:15]
    s_waitcnt lgkmcnt(3)
    v_pk_add_f32 v[16:17], v[16:17], v[20:21]
    v_pk_add_f32 v[18:19], v[18:19], v[22:23]
    s_waitcnt lgkmcnt(1)
    v_pk_add_f32 v[24:25], v[24:25], v[28:29]
    v_pk_add_f32 v[26:27], v[26:27], v[30:31]
    v_pk_add_f32 v[8:9], v[8:9], v[16:17]
    v_pk_add_f32 v[10:11], v[10:11], v[18:19]
    s_waitcnt lgkmcnt(0)
    v_pk_add_f32 v[24:25], v[24:25], v[32:33]
    v_pk_add_f32 v[26:27], v[26:27], v[34:35]
    v_pk_add_f32 v[8:9], v[8:9], v[24:25]
    v_pk_add_f32 v[10:11], v[10:11], v[26:27]
    s_cmp_ge_u32 s20, 28
    s_cbranch_scc1 K01_B1
    v_bfi_b32 v8, 1, v4, v8
    buffer_store_dwordx4 v[8:11], v1, s[12:15], s21 offen sc1
    s_barrier
    ds_read_b128 v[40:43], v1 offset:63488
    ds_read_b128 v[44:47], v1 offset:63744
    ds_read_b128 v[48:51], v1 offset:64000
    ds_read_b128 v[52:55], v1 offset:64256
    ds_read_b128 v[56:59], v1 offset:64512
    ds_read_b128 v[60:63], v1 offset:64768
    ds_read_b128 v[64:67], v1 offset:65024
    s_waitcnt lgkmcnt(5)
    v_pk_add_f32 v[40:41], v[40:41], v[44:45]
    v_pk_add_f32 v[42:43], v[42:43], v[46:47]
    s_waitcnt lgkmcnt(3)
    v_pk_add_f32 v[48:49], v[48:49], v[52:53]
    v_pk_add_f32 v[50:51], v[50:51], v[54:55]
    s_waitcnt lgkmcnt(1)
    v_pk_add_f32 v[56:57], v[56:57], v[60:61]
    v_pk_add_f32 v[58:59], v[58:59], v[62:63]
    v_pk_add_f32 v[40:41], v[40:41], v[48:49]
    v_pk_add_f32 v[42:43], v[42:43], v[50:51]
    s_waitcnt lgkmcnt(0)
    v_pk_add_f32 v[56:57], v[56:57], v[64:65]
    v_pk_add_f32 v[58:59], v[58:59], v[66:67]
    v_pk_add_f32 v[40:41], v[40:41], v[56:57]
    v_pk_add_f32 v[42:43], v[42:43], v[58:59]
    v_bfi_b32 v40, 1, v5, v40
    buffer_store_dwordx4 v[40:43], v1, s[12:15], s21 offen offset:3584 sc1
    s_branch K01_B2
K01_B1:
    s_barrier
    ds_read_b128 v[40:43], v1 offset:63488
    ds_read_b128 v[44:47], v1 offset:63744
    ds_read_b128 v[48:51], v1 offset:64000
    ds_read_b128 v[52:55], v1 offset:64256
    ds_read_b128 v[56:59], v1 offset:64512
    ds_read_b128 v[60:63], v1 offset:64768
    ds_read_b128 v[64:67], v1 offset:65024
    s_waitcnt lgkmcnt(5)
    v_pk_add_f32 v[40:41], v[40:41], v[44:45]
    v_pk_add_f32 v[42:43], v[42:43], v[46:47]
    s_waitcnt lgkmcnt(3)
    v_pk_add_f32 v[48:49], v[48:49], v[52:53]
    v_pk_add_f32 v[50:51], v[50:51], v[54:55]
    s_waitcnt lgkmcnt(1)
    v_pk_add_f32 v[56:57], v[56:57], v[60:61]
    v_pk_add_f32 v[58:59], v[58:59], v[62:63]
    v_pk_add_f32 v[40:41], v[40:41], v[48:49]
    v_pk_add_f32 v[42:43], v[42:43], v[50:51]
    s_waitcnt lgkmcnt(0)
    v_pk_add_f32 v[56:57], v[56:57], v[64:65]
    v_pk_add_f32 v[58:59], v[58:59], v[66:67]
    v_pk_add_f32 v[40:41], v[40:41], v[56:57]
    v_pk_add_f32 v[42:43], v[42:43], v[58:59]
    v_pk_add_f32 v[8:9], v[8:9], v[40:41]
    v_pk_add_f32 v[10:11], v[10:11], v[42:43]
    v_cvt_pk_bf16_f32 v12, v8, v9
    v_cvt_pk_bf16_f32 v13, v10, v11
    v_lshlrev_b32 v8, 16, v12
    v_and_b32 v9, 0xffff0000, v12
    v_lshlrev_b32 v10, 16, v13
    v_and_b32 v11, 0xffff0000, v13
    v_mul_f32 v8, s25, v8
    v_mul_f32 v9, s25, v9
    v_mul_f32 v10, s25, v10
    v_mul_f32 v11, s25, v11
    v_bfi_b32 v8, s26, v72, v8
    v_bfi_b32 v9, s26, v73, v9
    v_bfi_b32 v10, s26, v74, v10
    v_bfi_b32 v11, s26, v75, v11
    buffer_store_dwordx4 v[8:11], v1, s[12:15], s23 offen sc1
K01_B2:
    s_mov_b32 s90, 0
K01_PC2_L:
    buffer_load_dword v4, off, s[72:75], 0 sc1
    s_add_u32 s90, s90, 1
    s_cmp_gt_u32 s90, 200000
    s_cbranch_scc1 K01_PC2_E
    s_waitcnt vmcnt(0)
    v_cmp_ne_u32 vcc, 1, v4
    s_nop 1
    s_cbranch_vccnz K01_PC2_L
K01_PC2_E:
    s_lshl_b32 s88, s2, 7
    s_add_u32 s88, s88, 0x1f0000
    v_mov_b32 v5, 0x7fff0000
    v_writelane_b32 v5, 0, 0
    buffer_store_dword v4, v5, s[12:15], s88 offen sc1
    s_endpgm
.p2align 7
K01_F:
    s_load_dwordx4 s[68:71], s[0:1], 80
    s_load_dwordx4 s[32:35], s[0:1], 8
    s_load_dwordx2 s[6:7], s[0:1], 48
    s_lshr_b32 s3, s3, 6
    v_and_b32 v0, 63, v0
    v_lshlrev_b32 v1, 4, v0
    v_and_b32 v2, 15, v0
    v_lshrrev_b32 v3, 4, v0
    s_getpc_b64 s[36:37]
K01_PCF:
    s_sub_u32 s36, s36, K01_PCF-k01_kernel
    s_subb_u32 s37, s37, 0
    s_mov_b32 s39, 0x00020000
    s_sub_u32 s2, s2, 176
    s_add_u32 s3, s3, 7
    s_and_b32 s3, s3, 7
    s_mov_b32 s38, CODE_END-k01_kernel
    s_min_u32 s18, s3, 5
    s_lshl_b32 s18, s18, 10
    s_mov_b32 m0, s18
    s_add_u32 s18, s18, k1_tbl-k01_kernel
    s_and_b32 s19, s2, 7
    s_lshr_b32 s21, s2, 4
    buffer_load_dwordx4 v1, s[36:39], s18 offen lds
    s_lshl_b32 s21, s21, 3
    s_add_u32 s19, s19, s21
    s_bfe_u32 s48, s2, 0x10003
    s_lshl_b32 s56, s48, 12
    s_and_b32 s57, s2, 1
    s_lshl_b32 s57, s57, 14
    s_add_u32 s57, s57, 0x1d0000
    s_sub_u32 s21, 64, s19
    s_cmp_eq_u32 s19, 0
    s_cselect_b32 s21, 32, s21
    s_cmp_eq_u32 s48, 0
    s_cselect_b32 s21, s19, s21
    s_cmp_eq_u32 s2, 64
    s_cselect_b32 s2, 64, s21
    s_and_b32 s19, s19, 31
    v_and_b32 v46, 31, v0
    v_lshlrev_b32 v46, 4, v46
    v_cmp_gt_u32 vcc, 32, v0
    s_lshl_b32 s84, s3, 8
    s_add_u32 s84, s84, s2
    s_sub_u32 s85, 2048, s84
    s_and_b32 s85, s85, 2047
    s_mul_i32 s84, s84, 450
    s_mul_i32 s85, s85, 450
    v_mov_b32 v44, s85
    v_mov_b32 v47, s84
    v_cndmask_b32 v44, v44, v47, vcc
    v_and_b32 v44, -16, v44
    v_add_u32 v44, v44, v46
    s_lshl_b32 s86, s3, 8
    s_add_u32 s86, s86, s2
    s_add_u32 s86, s86, 128
    s_sub_u32 s87, 2048, s86
    s_and_b32 s87, s87, 2047
    s_mul_i32 s86, s86, 450
    s_mul_i32 s87, s87, 450
    v_mov_b32 v45, s87
    v_mov_b32 v47, s86
    v_cndmask_b32 v45, v45, v47, vcc
    v_and_b32 v45, -16, v45
    v_add_u32 v45, v45, v46
    s_lshl_b32 s28, s3, 13
    s_add_u32 s28, s28, 47104
    s_mov_b32 m0, s28
    s_waitcnt lgkmcnt(0)
    s_mov_b32 s40, s32
    s_mov_b32 s41, s33
    s_mov_b32 s42, 0xe1000
    s_mov_b32 s43, 0x00020000
    s_mov_b32 s44, s34
    s_mov_b32 s45, s35
    s_mov_b32 s46, 0xe1000
    s_mov_b32 s47, 0x00020000
    s_sub_u32 s17, s3, 1
    s_cmp_lt_u32 s17, 6
    s_cbranch_scc1 K1_N1
    buffer_load_dwordx4 v44, s[40:43], 0 offen nt lds
    s_add_u32 m0, m0, 1024
    s_nop 0
    buffer_load_dwordx4 v44, s[44:47], 0 offen nt lds
    s_add_u32 m0, m0, 1024
    s_nop 0
    buffer_load_dwordx4 v45, s[40:43], 0 offen nt lds
    s_add_u32 m0, m0, 1024
    s_nop 0
    buffer_load_dwordx4 v45, s[44:47], 0 offen nt lds
K1_N1:
    s_mov_b32 s12, s70
    s_mov_b32 s13, s71
    s_mov_b32 s14, 0x10000000
    s_mov_b32 s15, 0x00020000
    s_mov_b32 s72, s68
    s_mov_b32 s73, s69
    s_mov_b32 s74, 0x100
    s_mov_b32 s75, 0x00020000
    v_lshlrev_b32 v43, 5, v0
    s_add_u32 s54, s57, 2048
    s_mov_b32 s52, 0xa000
    s_mov_b32 s53, 0xbc00
    v_and_b32 v144, 0, v0
    v_mul_u32_u24 v144, 37, v144
    v_lshl_add_u32 v144, s2, 1, v144
    v_and_b32 v144, 127, v144
    v_lshlrev_b32 v144, 7, v144
    s_mov_b32 s16, 0x1d8000
    s_cmp_lg_u32 s3, 7
    s_cbranch_scc1 K1_N0
    s_cmp_lg_u32 s2, 0
    s_cbranch_scc1 K1_SG3
    v_mov_b32 v27, 0x7fff0000
    v_mul_u32_u24 v28, 448, v3
    v_lshl_add_u32 v28, v2, 2, v28
    v_cmp_gt_u32 vcc, 12, v2
    v_add_u32 v29, 64, v28
    s_nop 0
    v_cndmask_b32 v29, v27, v29, vcc
    s_mov_b32 s18, 0xd800
    buffer_load_dword v232, v28, s[12:15], s18 offen offset:0 sc1
    buffer_load_dword v233, v28, s[12:15], s18 offen offset:112 sc1
    buffer_load_dword v234, v28, s[12:15], s18 offen offset:224 sc1
    buffer_load_dword v235, v28, s[12:15], s18 offen offset:336 sc1
    buffer_load_dword v236, v29, s[12:15], s18 offen offset:0 sc1
    buffer_load_dword v237, v29, s[12:15], s18 offen offset:112 sc1
    buffer_load_dword v238, v29, s[12:15], s18 offen offset:224 sc1
    buffer_load_dword v239, v29, s[12:15], s18 offen offset:336 sc1
K1_SG3:
    buffer_load_dword v126, v1, s[12:15], s52 offen offset:0 sc1
    buffer_load_dword v127, v1, s[12:15], s52 offen offset:768 sc1
    buffer_load_dword v128, v1, s[12:15], s52 offen offset:1792 sc1
    buffer_load_dword v129, v1, s[12:15], s52 offen offset:2560 sc1
    buffer_load_dword v130, v1, s[12:15], s53 offen offset:0 sc1
    buffer_load_dword v131, v1, s[12:15], s53 offen offset:768 sc1
    buffer_load_dword v132, v1, s[12:15], s53 offen offset:1792 sc1
    buffer_load_dword v133, v1, s[12:15], s53 offen offset:2560 sc1
    buffer_load_dword v124, v43, s[12:15], s57 offen sc1
    buffer_load_dword v125, v43, s[12:15], s54 offen sc1
    buffer_load_dword v143, v144, s[12:15], s16 offen sc1
K1_N0:
    s_and_b32 s25, s2, 63
    s_cmp_gt_u32 s25, 32
    s_cselect_b32 s20, -1.0, 1.0
    s_cmp_eq_u32 s19, 0
    s_cselect_b32 s20, 0, s20
    s_mul_i32 s19, s19, 57344
    s_lshl_b32 s21, s3, 13
    s_add_u32 s19, s19, s21
    s_add_u32 s19, s19, 0x10000
    s_add_u32 s23, s21, 47104
    v_lshlrev_b32 v13, 7, v2
    v_add_u32 v13, s2, v13
    s_lshr_b32 s27, s3, 1
    s_lshl_b32 s27, s27, 3
    s_and_b32 s21, s3, 1
    s_add_u32 s27, s27, s21
    v_lshl_add_u32 v14, v3, 1, s27
    v_mul_u32_u24 v13, v13, v14
    v_cvt_f32_u32 v13, v13
    v_mul_f32 v13, 0x3a000000, v13
    v_sin_f32 v17, v13
    v_cos_f32 v18, v13
    s_lshr_b32 s27, s3, 2
    s_xor_b32 s27, s27, s48
    s_lshl_b32 s27, s27, 10
    s_and_b32 s21, s3, 3
    s_lshl_b32 s21, s21, 2
    s_add_u32 s27, s27, s21
    v_add_u32 v14, s27, v1
    v_mul_f32 v19, s20, v17
    v_mul_f32 v21, s20, v18
    v_cvt_pk_bf16_f32 v15, v18, v19
    v_cvt_pk_bf16_f32 v16, -v17, v21
    ds_write_b32 v14, v15 offset:43008
    ds_write_b32 v14, v16 offset:45056
    v_lshrrev_b32 v26, 1, v2
    v_lshl_add_u32 v24, v3, 6, v2
    v_lshlrev_b32 v24, 7, v24
    v_xor_b32 v25, s3, v26
    v_lshl_add_u32 v24, v25, 4, v24
    v_add_u32 v24, 6144, v24
    v_xor_b32 v26, v3, v26
    v_lshlrev_b32 v25, 7, v2
    v_lshl_add_u32 v25, v26, 4, v25
    s_lshl_b32 s27, s3, 12
    s_add_u32 s27, s27, 6144
    v_add_u32 v25, s27, v25
    v_xor_b32 v113, 64, v25
    s_and_b32 s27, s3, 6
    s_lshr_b32 s27, 0x78, s27
    s_and_b32 s27, s27, 3
    v_xor_b32 v114, s27, v3
    v_mul_u32_u24 v26, 1040, v2
    v_lshl_add_u32 v26, v114, 4, v26
    s_lshl_b32 s27, s3, 7
    s_add_u32 s27, s27, 47104
    v_add_u32 v26, s27, v26
    v_lshrrev_b32 v114, 1, v2
    v_and_b32 v114, 6, v114
    s_movk_i32 s27, 0x78
    v_bfe_u32 v114, s27, v114, 2
    v_xor_b32 v114, v3, v114
    v_lshrrev_b32 v8, 3, v0
    v_lshlrev_b32 v9, 8, v8
    v_and_b32 v10, 3, v0
    v_lshl_add_u32 v9, v10, 6, v9
    v_bfe_u32 v10, v0, 2, 1
    s_cmp_eq_u32 s25, 32
    s_cselect_b32 s27, 1, 0
    v_xor_b32 v10, s27, v10
    v_lshl_add_u32 v9, v10, 3, v9
    v_add_u32 v9, s23, v9
    v_and_b32 v8, 3, v8
    v_lshl_add_u32 v4, v8, 4, v9
    v_xor_b32 v5, 16, v4
    v_xor_b32 v6, 32, v4
    v_xor_b32 v7, 48, v4
    s_lshl_b32 s51, s3, 4
    s_add_u32 s51, s51, 112704
    v_mul_u32_u24 v28, 448, v3
    v_add_u32 v28, s51, v28
    v_mul_u32_u24 v122, 112, v2
    v_add_u32 v122, s51, v122
    s_lshl_b32 s27, s3, 1
    s_and_b32 s27, s27, 12
    s_add_u32 s27, s27, 112640
    v_mov_b32 v123, s27
    v_mov_b32 v112, -1
    v_lshlrev_b32 v30, 9, v3
    v_add_u32 v30, s2, v30
    v_mul_u32_u24 v30, v30, v2
    v_cvt_f32_u32 v30, v30
    v_mul_f32 v30, 0x3a000000, v30
    v_cvt_f32_u32 v31, v2
    v_mul_f32 v31, 0x3d800000, v31
    v_sin_f32 v84, v30
    v_cos_f32 v80, v30
    v_add_f32 v30, v30, v31
    v_sin_f32 v85, v30
    v_cos_f32 v81, v30
    v_add_f32 v30, v30, v31
    v_sin_f32 v86, v30
    v_cos_f32 v82, v30
    v_add_f32 v30, v30, v31
    v_sin_f32 v87, v30
    v_cos_f32 v83, v30
    v_lshrrev_b32 v27, 2, v2
    v_mul_u32_u24 v27, 28672, v27
    v_and_b32 v31, 3, v2
    v_lshl_add_u32 v27, v31, 4, v27
    v_mul_u32_u24 v31, 460288, v3
    v_add_u32 v27, v27, v31
    v_lshlrev_b32 v29, 6, v2
    v_lshl_add_u32 v29, v114, 4, v29
    s_mul_i32 s27, s3, 4160
    s_add_u32 s27, s27, 47104
    v_add_u32 v29, s27, v29
    s_sub_u32 s24, 64, s2
    s_min_u32 s24, s24, s2
    s_and_b32 s24, s24, 30
    s_add_u32 s24, s24, s48
    s_and_b32 s27, s2, 1
    s_lshl_b32 s27, s27, 5
    s_add_u32 s24, s24, s27
    s_lshl_b32 s24, s24, 6
    s_lshl_b32 s27, s3, 12
    s_add_u32 s24, s24, s27
    s_add_u32 s60, s24, 0x400000
    s_add_u32 s61, s24, 0x41c180
    s_add_u32 s62, s24, 0x438300
    s_add_u32 s63, s24, 0x454480
    v_cvt_pk_bf16_f32 v116, -v84, -v85
    v_cvt_pk_bf16_f32 v117, -v86, -v87
    v_cvt_pk_bf16_f32 v118, v80, v81
    v_cvt_pk_bf16_f32 v119, v82, v83
    v_cvt_pk_bf16_f32 v120, v84, v85
    v_cvt_pk_bf16_f32 v121, v86, v87
    v_mov_b32 v96, 0
    v_mov_b32 v97, 0
    v_mov_b32 v98, 0
    v_mov_b32 v99, 0
    v_add_u32 v30, 120832, v1
    s_or_b32 s55, s2, s3
    ds_write2_b32 v123, v112, v96 offset0:0 offset1:4
    v_lshlrev_b32 v48, 7, v3
    v_lshl_add_u32 v48, v2, 1, v48
    v_sub_u32 v49, 288, v48
    v_max_i32 v49, 0, v49
    v_cmp_eq_u32 vcc, 3, v3
    v_add_u32 v51, 64, v48
    v_sub_u32 v52, 832, v48
    v_cndmask_b32 v51, v51, v52, vcc
    v_add_u32 v52, 96, v48
    v_sub_u32 v53, 800, v48
    v_cndmask_b32 v52, v52, v53, vcc
    v_mov_b32 v53, 0
    v_bfrev_b32 v54, 1
    v_cndmask_b32 v60, v53, v54, vcc
    v_cmp_eq_u32 s[80:81], 0, v0
    v_cmp_eq_u32 s[82:83], 48, v0
    s_nop 0
    v_cndmask_b32 v61, v53, v54, s[80:81]
    s_and_b32 s29, s84, 15
    s_add_u32 s29, s29, s28
    s_and_b32 s30, s85, 15
    s_add_u32 s30, s30, s28
    s_add_u32 s30, s30, 512
    v_mov_b32 v55, s29
    v_mov_b32 v56, s30
    v_cndmask_b32 v57, v55, v56, vcc
    v_add_u32 v33, v57, v51
    v_add_u32 v34, v57, v52
    v_add_u32 v55, 448, v55
    v_cndmask_b32 v36, v55, v56, s[80:81]
    v_add_u32 v32, s29, v48
    v_add_u32 v35, s30, v49
    s_and_b32 s29, s86, 15
    s_add_u32 s29, s29, s28
    s_and_b32 s30, s87, 15
    s_add_u32 s30, s30, s28
    s_add_u32 s30, s30, 512
    v_mov_b32 v55, s29
    v_mov_b32 v56, s30
    v_cndmask_b32 v57, v55, v56, vcc
    v_add_u32 v38, v57, v51
    v_add_u32 v39, v57, v52
    v_add_u32 v55, 448, v55
    v_cndmask_b32 v41, v55, v56, s[80:81]
    v_add_u32 v37, s29, v48
    v_add_u32 v40, s30, v49
    s_mov_b32 s21, 0xffff0000
    s_cmp_eq_u32 s3, 7
    s_cbranch_scc1 K1_T7
    s_cmp_lt_u32 s17, 6
    s_cbranch_scc0 K1_N2
    s_waitcnt vmcnt(0)
    buffer_load_dwordx4 v44, s[40:43], 0 offen nt lds
    s_add_u32 m0, m0, 1024
    s_nop 0
    buffer_load_dwordx4 v44, s[44:47], 0 offen nt lds
    s_add_u32 m0, m0, 1024
    s_nop 0
    buffer_load_dwordx4 v45, s[40:43], 0 offen nt lds
    s_add_u32 m0, m0, 1024
    s_nop 0
    buffer_load_dwordx4 v45, s[44:47], 0 offen nt lds
K1_N2:
    s_waitcnt vmcnt(4) lgkmcnt(0)
    s_barrier
    v_cvt_f32_u32 v80, v2
    v_mul_f32 v80, 0x3b124925, v80
    s_lshl_b32 s27, s3, 2
    v_mul_u32_u24 v81, 112, v3
    v_add_u32 v81, s27, v81
    v_cvt_f32_u32 v81, v81
    v_mul_f32 v81, v81, v80
    v_mul_f32 v82, 0x41e00000, v80
    v_cos_f32 v84, v82
    v_sin_f32 v86, v82
    v_cos_f32 v124, v81
    v_sin_f32 v140, v81
    v_add_f32 v81, v81, v80
    v_cos_f32 v125, v81
    v_sin_f32 v141, v81
    v_add_f32 v81, v81, v80
    v_cos_f32 v126, v81
    v_sin_f32 v142, v81
    v_add_f32 v81, v81, v80
    v_cos_f32 v127, v81
    v_sin_f32 v143, v81
    v_mul_u32_u24 v80, 28, v2
    v_add_u32 v80, s27, v80
    v_cvt_f32_u32 v80, v80
    v_mul_f32 v80, 0x3b124925, v80
    v_lshlrev_b32 v82, 2, v3
    v_cvt_f32_u32 v82, v82
    v_mul_f32 v81, v82, v80
    v_cos_f32 v88, v80
    v_sin_f32 v92, v80
    v_cos_f32 v172, v81
    v_sin_f32 v188, v81
    v_add_f32 v80, 0x3b124925, v80
    v_mul_f32 v81, v82, v80
    v_cos_f32 v89, v80
    v_sin_f32 v93, v80
    v_cos_f32 v173, v81
    v_sin_f32 v189, v81
    v_add_f32 v80, 0x3b124925, v80
    v_mul_f32 v81, v82, v80
    v_cos_f32 v90, v80
    v_sin_f32 v94, v80
    v_cos_f32 v174, v81
    v_sin_f32 v190, v81
    v_add_f32 v80, 0x3b124925, v80
    v_mul_f32 v81, v82, v80
    v_cos_f32 v91, v80
    v_sin_f32 v95, v80
    v_cos_f32 v175, v81
    v_sin_f32 v191, v81
    v_pk_mul_f32 v[128:129], v[140:141], v[86:87] op_sel_hi:[1,0]
    v_pk_mul_f32 v[144:145], v[124:125], v[86:87] op_sel_hi:[1,0]
    v_pk_fma_f32 v[128:129], v[124:125], v[84:85], v[128:129] op_sel_hi:[1,0,1] neg_lo:[0,0,1] neg_hi:[0,0,1]
    v_pk_fma_f32 v[144:145], v[140:141], v[84:85], v[144:145] op_sel_hi:[1,0,1]
    v_pk_mul_f32 v[130:131], v[142:143], v[86:87] op_sel_hi:[1,0]
    v_pk_mul_f32 v[146:147], v[126:127], v[86:87] op_sel_hi:[1,0]
    v_pk_fma_f32 v[130:131], v[126:127], v[84:85], v[130:131] op_sel_hi:[1,0,1] neg_lo:[0,0,1] neg_hi:[0,0,1]
    v_pk_fma_f32 v[146:147], v[142:143], v[84:85], v[146:147] op_sel_hi:[1,0,1]
    v_pk_mul_f32 v[132:133], v[144:145], v[86:87] op_sel_hi:[1,0]
    v_pk_mul_f32 v[232:233], v[128:129], v[86:87] op_sel_hi:[1,0]
    v_pk_fma_f32 v[132:133], v[128:129], v[84:85], v[132:133] op_sel_hi:[1,0,1] neg_lo:[0,0,1] neg_hi:[0,0,1]
    v_pk_fma_f32 v[232:233], v[144:145], v[84:85], v[232:233] op_sel_hi:[1,0,1]
    v_pk_mul_f32 v[134:135], v[146:147], v[86:87] op_sel_hi:[1,0]
    v_pk_mul_f32 v[234:235], v[130:131], v[86:87] op_sel_hi:[1,0]
    v_pk_fma_f32 v[134:135], v[130:131], v[84:85], v[134:135] op_sel_hi:[1,0,1] neg_lo:[0,0,1] neg_hi:[0,0,1]
    v_pk_fma_f32 v[234:235], v[146:147], v[84:85], v[234:235] op_sel_hi:[1,0,1]
    v_pk_mul_f32 v[136:137], v[232:233], v[86:87] op_sel_hi:[1,0]
    v_pk_mul_f32 v[236:237], v[132:133], v[86:87] op_sel_hi:[1,0]
    v_pk_fma_f32 v[136:137], v[132:133], v[84:85], v[136:137] op_sel_hi:[1,0,1] neg_lo:[0,0,1] neg_hi:[0,0,1]
    v_pk_fma_f32 v[236:237], v[232:233], v[84:85], v[236:237] op_sel_hi:[1,0,1]
    v_pk_mul_f32 v[138:139], v[234:235], v[86:87] op_sel_hi:[1,0]
    v_pk_mul_f32 v[238:239], v[134:135], v[86:87] op_sel_hi:[1,0]
    v_pk_fma_f32 v[138:139], v[134:135], v[84:85], v[138:139] op_sel_hi:[1,0,1] neg_lo:[0,0,1] neg_hi:[0,0,1]
    v_pk_fma_f32 v[238:239], v[234:235], v[84:85], v[238:239] op_sel_hi:[1,0,1]
    v_pk_mul_f32 v[176:177], v[188:189], v[92:93]
    v_pk_mul_f32 v[192:193], v[172:173], v[92:93]
    v_pk_fma_f32 v[176:177], v[172:173], v[88:89], v[176:177] neg_lo:[0,0,1] neg_hi:[0,0,1]
    v_pk_fma_f32 v[192:193], v[188:189], v[88:89], v[192:193]
    v_pk_mul_f32 v[178:179], v[190:191], v[94:95]
    v_pk_mul_f32 v[194:195], v[174:175], v[94:95]
    v_pk_fma_f32 v[178:179], v[174:175], v[90:91], v[178:179] neg_lo:[0,0,1] neg_hi:[0,0,1]
    v_pk_fma_f32 v[194:195], v[190:191], v[90:91], v[194:195]
    v_pk_mul_f32 v[180:181], v[192:193], v[92:93]
    v_pk_mul_f32 v[240:241], v[176:177], v[92:93]
    v_pk_fma_f32 v[180:181], v[176:177], v[88:89], v[180:181] neg_lo:[0,0,1] neg_hi:[0,0,1]
    v_pk_fma_f32 v[240:241], v[192:193], v[88:89], v[240:241]
    v_pk_mul_f32 v[182:183], v[194:195], v[94:95]
    v_pk_mul_f32 v[242:243], v[178:179], v[94:95]
    v_pk_fma_f32 v[182:183], v[178:179], v[90:91], v[182:183] neg_lo:[0,0,1] neg_hi:[0,0,1]
    v_pk_fma_f32 v[242:243], v[194:195], v[90:91], v[242:243]
    v_pk_mul_f32 v[184:185], v[240:241], v[92:93]
    v_pk_mul_f32 v[244:245], v[180:181], v[92:93]
    v_pk_fma_f32 v[184:185], v[180:181], v[88:89], v[184:185] neg_lo:[0,0,1] neg_hi:[0,0,1]
    v_pk_fma_f32 v[244:245], v[240:241], v[88:89], v[244:245]
    v_pk_mul_f32 v[186:187], v[242:243], v[94:95]
    v_pk_mul_f32 v[246:247], v[182:183], v[94:95]
    v_pk_fma_f32 v[186:187], v[182:183], v[90:91], v[186:187] neg_lo:[0,0,1] neg_hi:[0,0,1]
    v_pk_fma_f32 v[246:247], v[242:243], v[90:91], v[246:247]
    s_waitcnt vmcnt(0)
K1_RP:
    ds_read_u16 v196, v32 offset:0
    ds_read_u16 v197, v32 offset:32
    ds_read_u16 v198, v33 offset:0
    ds_read_u16 v199, v34 offset:0
    ds_read_u16 v200, v35 offset:96
    ds_read_u16 v201, v35 offset:64
    ds_read_u16 v202, v35 offset:32
    ds_read_u16 v203, v35 offset:0
    ds_read_u16 v204, v36 offset:0
    ds_read_u16 v205, v32 offset:1024
    ds_read_u16 v206, v32 offset:1056
    ds_read_u16 v207, v33 offset:1024
    ds_read_u16 v208, v34 offset:1024
    ds_read_u16 v209, v35 offset:1120
    ds_read_u16 v210, v35 offset:1088
    ds_read_u16 v211, v35 offset:1056
    ds_read_u16 v212, v35 offset:1024
    ds_read_u16 v213, v36 offset:1024
    ds_read_u16 v214, v37 offset:2048
    ds_read_u16 v215, v37 offset:2080
    ds_read_u16 v216, v38 offset:2048
    ds_read_u16 v217, v39 offset:2048
    ds_read_u16 v218, v40 offset:2144
    ds_read_u16 v219, v40 offset:2112
    ds_read_u16 v220, v40 offset:2080
    ds_read_u16 v221, v40 offset:2048
    ds_read_u16 v222, v41 offset:2048
    ds_read_u16 v223, v37 offset:3072
    ds_read_u16 v224, v37 offset:3104
    ds_read_u16 v225, v38 offset:3072
    ds_read_u16 v226, v39 offset:3072
    ds_read_u16 v227, v40 offset:3168
    ds_read_u16 v228, v40 offset:3136
    ds_read_u16 v229, v40 offset:3104
    ds_read_u16 v230, v40 offset:3072
    ds_read_u16 v231, v41 offset:3072
    s_waitcnt lgkmcnt(15)
    v_lshl_or_b32 v8, v205, 16, v196
    v_lshl_or_b32 v9, v206, 16, v197
    v_lshl_or_b32 v10, v207, 16, v198
    v_lshl_or_b32 v11, v208, 16, v199
    v_lshl_or_b32 v12, v209, 16, v200
    v_lshl_or_b32 v13, v210, 16, v201
    v_lshl_or_b32 v14, v211, 16, v202
    v_lshl_or_b32 v15, v212, 16, v203
    v_lshl_or_b32 v55, v213, 16, v204
    v_xor_b32 v12, v54, v12
    v_xor_b32 v13, v54, v13
    v_xor_b32 v14, v54, v14
    v_xor_b32 v15, v54, v15
    v_xor_b32 v10, v60, v10
    v_xor_b32 v11, v60, v11
    v_xor_b32 v55, v61, v55
    v_lshlrev_b32 v56, 16, v55
    v_and_b32 v57, 0xffff0000, v55
    v_lshlrev_b32 v58, 16, v8
    v_and_b32 v59, 0xffff0000, v8
    v_pk_add_f32 v[58:59], v[58:59], v[56:57]
    v_pk_mul_f32 v[58:59], v[58:59], 0.5 op_sel_hi:[1,0]
    v_cvt_pk_bf16_f32 v58, v58, v59
    v_cndmask_b32 v8, v8, v58, s[80:81]
    v_lshlrev_b32 v58, 16, v10
    v_and_b32 v59, 0xffff0000, v10
    v_pk_add_f32 v[58:59], v[58:59], v[56:57]
    v_pk_mul_f32 v[58:59], v[58:59], 0.5 op_sel_hi:[1,0]
    v_cvt_pk_bf16_f32 v58, v58, v59
    v_cndmask_b32 v10, v10, v58, s[82:83]
    s_waitcnt lgkmcnt(0)
    v_lshl_or_b32 v16, v223, 16, v214
    v_lshl_or_b32 v17, v224, 16, v215
    v_lshl_or_b32 v18, v225, 16, v216
    v_lshl_or_b32 v19, v226, 16, v217
    v_lshl_or_b32 v20, v227, 16, v218
    v_lshl_or_b32 v21, v228, 16, v219
    v_lshl_or_b32 v22, v229, 16, v220
    v_lshl_or_b32 v23, v230, 16, v221
    v_lshl_or_b32 v55, v231, 16, v222
    v_xor_b32 v20, v54, v20
    v_xor_b32 v21, v54, v21
    v_xor_b32 v22, v54, v22
    v_xor_b32 v23, v54, v23
    v_xor_b32 v18, v60, v18
    v_xor_b32 v19, v60, v19
    v_xor_b32 v55, v61, v55
    v_lshlrev_b32 v56, 16, v55
    v_and_b32 v57, 0xffff0000, v55
    v_lshlrev_b32 v58, 16, v16
    v_and_b32 v59, 0xffff0000, v16
    v_pk_add_f32 v[58:59], v[58:59], v[56:57]
    v_pk_mul_f32 v[58:59], v[58:59], 0.5 op_sel_hi:[1,0]
    v_cvt_pk_bf16_f32 v58, v58, v59
    v_cndmask_b32 v16, v16, v58, s[80:81]
    v_lshlrev_b32 v58, 16, v18
    v_and_b32 v59, 0xffff0000, v18
    v_pk_add_f32 v[58:59], v[58:59], v[56:57]
    v_pk_mul_f32 v[58:59], v[58:59], 0.5 op_sel_hi:[1,0]
    v_cvt_pk_bf16_f32 v58, v58, v59
    v_cndmask_b32 v18, v18, v58, s[82:83]
    ds_read_b128 v[148:151], v1 offset:0
    ds_read_b128 v[152:155], v1 offset:1024
    ds_read_b128 v[156:159], v1 offset:2048
    ds_read_b128 v[160:163], v1 offset:3072
    ds_read_b128 v[164:167], v1 offset:4096
    ds_read_b128 v[168:171], v1 offset:5120
    v_lshlrev_b32 v96, 16, v8
    v_and_b32 v8, s21, v8
    v_lshlrev_b32 v97, 16, v9
    v_and_b32 v9, s21, v9
    v_lshlrev_b32 v98, 16, v10
    v_and_b32 v10, s21, v10
    v_lshlrev_b32 v99, 16, v11
    v_and_b32 v11, s21, v11
    v_lshlrev_b32 v100, 16, v12
    v_and_b32 v12, s21, v12
    v_lshlrev_b32 v101, 16, v13
    v_and_b32 v13, s21, v13
    v_lshlrev_b32 v102, 16, v14
    v_and_b32 v14, s21, v14
    v_lshlrev_b32 v103, 16, v15
    v_and_b32 v15, s21, v15
    v_lshlrev_b32 v104, 16, v16
    v_and_b32 v16, s21, v16
    v_lshlrev_b32 v105, 16, v17
    v_and_b32 v17, s21, v17
    v_lshlrev_b32 v106, 16, v18
    v_and_b32 v18, s21, v18
    v_lshlrev_b32 v107, 16, v19
    v_and_b32 v19, s21, v19
    v_lshlrev_b32 v108, 16, v20
    v_and_b32 v20, s21, v20
    v_lshlrev_b32 v109, 16, v21
    v_and_b32 v21, s21, v21
    v_lshlrev_b32 v110, 16, v22
    v_and_b32 v22, s21, v22
    v_lshlrev_b32 v111, 16, v23
    v_and_b32 v23, s21, v23
    s_cmp_eq_u32 s3, 7
    s_cbranch_scc1 K1_W7
    ds_read_b128 v[64:67], v1 offset:43008
    ds_read_b128 v[68:71], v1 offset:44032
    ds_read_b128 v[72:75], v1 offset:45056
    ds_read_b128 v[76:79], v1 offset:46080
    s_mov_b32 s90, 0
    s_mov_b32 s52, 0x11111111
K1_S0:
    ds_read2_b32 v[32:33], v123 offset0:0 offset1:4
    s_add_u32 s90, s90, 1
    s_cmp_gt_u32 s90, 200000
    s_cbranch_scc1 K1_S2
    s_waitcnt lgkmcnt(0)
    v_cmp_eq_u32 vcc, 0, v33
    v_readfirstlane_b32 s48, v32
    s_nop 0
    s_lshr_b32 s49, s48, 1
    s_or_b32 s48, s48, s49
    s_lshr_b32 s49, s48, 2
    s_or_b32 s48, s48, s49
    s_cselect_b32 s48, -1, 0
    s_andn2_b32 s48, s52, s48
    s_cbranch_scc0 K1_U0_E
    s_xor_b32 s52, s52, s48
K1_U0_L:
    s_ff1_i32_b32 s49, s48
    s_bitset0_b32 s48, s49
    s_lshl_b32 s49, s49, 8
    s_add_u32 m0, s23, s49
    s_xor_b32 s49, s49, s56
    s_add_u32 s49, s19, s49
    s_cmp_lg_u32 s48, 0
    buffer_load_dwordx4 v1, s[12:15], s49 offen sc1 lds
    s_cbranch_scc1 K1_U0_L
K1_U0_E:
    s_cbranch_vccnz K1_S0
K1_S2:
    ds_read_b128 v[80:83], v28 offset:0
    ds_read_b128 v[84:87], v28 offset:112
    ds_read_b128 v[88:91], v28 offset:224
    ds_read_b128 v[92:95], v28 offset:336
    ds_read_b128 v[196:199], v122 offset:1792
    s_waitcnt lgkmcnt(4)
    v_pk_mul_f32 v[200:201], v[124:125], v[80:81]
    v_pk_mul_f32 v[202:203], v[126:127], v[82:83]
    v_pk_mul_f32 v[216:217], v[140:141], v[80:81]
    v_pk_mul_f32 v[218:219], v[142:143], v[82:83]
    s_waitcnt lgkmcnt(3)
    v_pk_mul_f32 v[204:205], v[128:129], v[84:85]
    v_pk_mul_f32 v[206:207], v[130:131], v[86:87]
    v_pk_mul_f32 v[220:221], v[144:145], v[84:85]
    v_pk_mul_f32 v[222:223], v[146:147], v[86:87]
    s_waitcnt lgkmcnt(2)
    v_pk_mul_f32 v[208:209], v[132:133], v[88:89]
    v_pk_mul_f32 v[210:211], v[134:135], v[90:91]
    v_pk_mul_f32 v[224:225], v[232:233], v[88:89]
    v_pk_mul_f32 v[226:227], v[234:235], v[90:91]
    s_waitcnt lgkmcnt(1)
    v_pk_mul_f32 v[212:213], v[136:137], v[92:93]
    v_pk_mul_f32 v[214:215], v[138:139], v[94:95]
    v_pk_mul_f32 v[228:229], v[236:237], v[92:93]
    v_pk_mul_f32 v[230:231], v[238:239], v[94:95]
    v_cvt_pk_bf16_f32 v124, -v216, -v220
    v_cvt_pk_bf16_f32 v126, v200, v204
    v_cvt_pk_bf16_f32 v128, v216, v220
    v_cvt_pk_bf16_f32 v125, -v224, -v228
    v_cvt_pk_bf16_f32 v127, v208, v212
    v_cvt_pk_bf16_f32 v129, v224, v228
    v_cvt_pk_bf16_f32 v130, -v217, -v221
    v_cvt_pk_bf16_f32 v132, v201, v205
    v_cvt_pk_bf16_f32 v134, v217, v221
    v_cvt_pk_bf16_f32 v131, -v225, -v229
    v_cvt_pk_bf16_f32 v133, v209, v213
    v_cvt_pk_bf16_f32 v135, v225, v229
    ds_read_b32 v32, v123
    v_cvt_pk_bf16_f32 v136, -v218, -v222
    v_cvt_pk_bf16_f32 v138, v202, v206
    v_cvt_pk_bf16_f32 v140, v218, v222
    v_cvt_pk_bf16_f32 v137, -v226, -v230
    v_cvt_pk_bf16_f32 v139, v210, v214
    v_cvt_pk_bf16_f32 v141, v226, v230
    v_cvt_pk_bf16_f32 v142, -v219, -v223
    v_cvt_pk_bf16_f32 v144, v203, v207
    v_cvt_pk_bf16_f32 v146, v219, v223
    v_cvt_pk_bf16_f32 v143, -v227, -v231
    v_cvt_pk_bf16_f32 v145, v211, v215
    v_cvt_pk_bf16_f32 v147, v227, v231
    s_waitcnt lgkmcnt(0)
    v_readfirstlane_b32 s48, v32
    s_nop 0
    s_lshr_b32 s49, s48, 1
    s_or_b32 s48, s48, s49
    s_lshr_b32 s49, s48, 2
    s_or_b32 s48, s48, s49
    s_cselect_b32 s48, -1, 0
    s_andn2_b32 s48, s52, s48
    s_cbranch_scc0 K1_U2_E
    s_xor_b32 s52, s52, s48
K1_U2_L:
    s_ff1_i32_b32 s49, s48
    s_bitset0_b32 s48, s49
    s_lshl_b32 s49, s49, 8
    s_add_u32 m0, s23, s49
    s_xor_b32 s49, s49, s56
    s_add_u32 s49, s19, s49
    s_cmp_lg_u32 s48, 0
    buffer_load_dwordx4 v1, s[12:15], s49 offen sc1 lds
    s_cbranch_scc1 K1_U2_L
K1_U2_E:
    v_pk_mul_f32 v[200:201], v[172:173], v[196:197]
    v_pk_mul_f32 v[202:203], v[174:175], v[198:199]
    v_pk_mul_f32 v[216:217], v[188:189], v[196:197]
    v_pk_mul_f32 v[218:219], v[190:191], v[198:199]
    v_pk_mul_f32 v[204:205], v[176:177], v[196:197]
    v_pk_mul_f32 v[206:207], v[178:179], v[198:199]
    v_pk_mul_f32 v[220:221], v[192:193], v[196:197]
    v_pk_mul_f32 v[222:223], v[194:195], v[198:199]
    v_pk_mul_f32 v[208:209], v[180:181], v[196:197]
    v_pk_mul_f32 v[210:211], v[182:183], v[198:199]
    v_pk_mul_f32 v[224:225], v[240:241], v[196:197]
    v_pk_mul_f32 v[226:227], v[242:243], v[198:199]
    v_pk_mul_f32 v[212:213], v[184:185], v[196:197]
    v_pk_mul_f32 v[214:215], v[186:187], v[198:199]
    v_pk_mul_f32 v[228:229], v[244:245], v[196:197]
    v_pk_mul_f32 v[230:231], v[246:247], v[198:199]
    v_cvt_pk_bf16_f32 v172, -v216, -v220
    v_cvt_pk_bf16_f32 v174, v200, v204
    v_cvt_pk_bf16_f32 v176, v216, v220
    v_cvt_pk_bf16_f32 v173, -v224, -v228
    v_cvt_pk_bf16_f32 v175, v208, v212
    v_cvt_pk_bf16_f32 v177, v224, v228
    v_cvt_pk_bf16_f32 v178, -v217, -v221
    v_cvt_pk_bf16_f32 v180, v201, v205
    v_cvt_pk_bf16_f32 v182, v217, v221
    v_cvt_pk_bf16_f32 v179, -v225, -v229
    v_cvt_pk_bf16_f32 v181, v209, v213
    v_cvt_pk_bf16_f32 v183, v225, v229
    v_cvt_pk_bf16_f32 v184, -v218, -v222
    v_cvt_pk_bf16_f32 v186, v202, v206
    v_cvt_pk_bf16_f32 v188, v218, v222
    v_cvt_pk_bf16_f32 v185, -v226, -v230
    v_cvt_pk_bf16_f32 v187, v210, v214
    v_cvt_pk_bf16_f32 v189, v226, v230
    v_cvt_pk_bf16_f32 v190, -v219, -v223
    v_cvt_pk_bf16_f32 v192, v203, v207
    v_cvt_pk_bf16_f32 v194, v219, v223
    v_cvt_pk_bf16_f32 v191, -v227, -v231
    v_cvt_pk_bf16_f32 v193, v211, v215
    v_cvt_pk_bf16_f32 v195, v227, v231
K1_S3:
    ds_read_b32 v32, v123
    s_add_u32 s90, s90, 1
    s_cmp_gt_u32 s90, 200000
    s_cbranch_scc1 K1_GO
    s_waitcnt lgkmcnt(0)
    v_readfirstlane_b32 s48, v32
    s_nop 0
    s_lshr_b32 s49, s48, 1
    s_or_b32 s48, s48, s49
    s_lshr_b32 s49, s48, 2
    s_or_b32 s48, s48, s49
    s_cselect_b32 s48, -1, 0
    s_andn2_b32 s48, s52, s48
    s_cbranch_scc0 K1_U1_E
    s_xor_b32 s52, s52, s48
K1_U1_L:
    s_ff1_i32_b32 s49, s48
    s_bitset0_b32 s48, s49
    s_lshl_b32 s49, s49, 8
    s_add_u32 m0, s23, s49
    s_xor_b32 s49, s49, s56
    s_add_u32 s49, s19, s49
    s_cmp_lg_u32 s48, 0
    buffer_load_dwordx4 v1, s[12:15], s49 offen sc1 lds
    s_cbranch_scc1 K1_U1_L
K1_U1_E:
    s_cmp_lg_u32 s52, 0
    s_cbranch_scc1 K1_S3
K1_GO:
    s_mov_b64 vcc, 0
K1_GO2:
    s_waitcnt vmcnt(4)
    ds_read_b64_tr_b16 v[32:33], v4 offset:0
    ds_read_b64_tr_b16 v[34:35], v4 offset:2048
    ds_read_b64_tr_b16 v[40:41], v5 offset:0
    ds_read_b64_tr_b16 v[42:43], v5 offset:2048
    ds_read_b64_tr_b16 v[48:49], v6 offset:0
    ds_read_b64_tr_b16 v[50:51], v6 offset:2048
    ds_read_b64_tr_b16 v[56:57], v7 offset:0
    ds_read_b64_tr_b16 v[58:59], v7 offset:2048
    s_waitcnt lgkmcnt(6)
    v_mfma_f32_16x16x32_bf16 v[200:203], v[32:35], v[64:67], 0
    v_mfma_f32_16x16x32_bf16 v[204:207], v[32:35], v[72:75], 0
    s_waitcnt lgkmcnt(4)
    v_mfma_f32_16x16x32_bf16 v[208:211], v[40:43], v[64:67], 0
    v_mfma_f32_16x16x32_bf16 v[212:215], v[40:43], v[72:75], 0
    s_waitcnt vmcnt(0)
    ds_read_b64_tr_b16 v[36:37], v4 offset:4096
    ds_read_b64_tr_b16 v[38:39], v4 offset:6144
    ds_read_b64_tr_b16 v[44:45], v5 offset:4096
    ds_read_b64_tr_b16 v[46:47], v5 offset:6144
    ds_read_b64_tr_b16 v[52:53], v6 offset:4096
    ds_read_b64_tr_b16 v[54:55], v6 offset:6144
    ds_read_b64_tr_b16 v[60:61], v7 offset:4096
    ds_read_b64_tr_b16 v[62:63], v7 offset:6144
    s_waitcnt lgkmcnt(10)
    v_mfma_f32_16x16x32_bf16 v[216:219], v[48:51], v[64:67], 0
    v_mfma_f32_16x16x32_bf16 v[220:223], v[48:51], v[72:75], 0
    s_waitcnt lgkmcnt(8)
    v_mfma_f32_16x16x32_bf16 v[224:227], v[56:59], v[64:67], 0
    v_mfma_f32_16x16x32_bf16 v[228:231], v[56:59], v[72:75], 0
    s_waitcnt lgkmcnt(6)
    v_mfma_f32_16x16x32_bf16 v[200:203], v[36:39], v[68:71], v[200:203]
    v_mfma_f32_16x16x32_bf16 v[204:207], v[36:39], v[76:79], v[204:207]
    s_waitcnt lgkmcnt(4)
    v_mfma_f32_16x16x32_bf16 v[208:211], v[44:47], v[68:71], v[208:211]
    v_mfma_f32_16x16x32_bf16 v[212:215], v[44:47], v[76:79], v[212:215]
    s_waitcnt lgkmcnt(2)
    v_mfma_f32_16x16x32_bf16 v[216:219], v[52:55], v[68:71], v[216:219]
    v_mfma_f32_16x16x32_bf16 v[220:223], v[52:55], v[76:79], v[220:223]
    s_waitcnt lgkmcnt(0)
    v_mfma_f32_16x16x32_bf16 v[224:227], v[60:63], v[68:71], v[224:227]
    v_cvt_pk_bf16_f32 v32, v200, v201
    v_cvt_pk_bf16_f32 v33, v202, v203
    v_mfma_f32_16x16x32_bf16 v[228:231], v[60:63], v[76:79], v[228:231]
    v_cvt_pk_bf16_f32 v34, v204, v205
    v_cvt_pk_bf16_f32 v35, v206, v207
    s_nop 1
    v_mfma_f32_16x16x32_bf16 v[200:203], v[32:35], v[126:129], 0
    v_cvt_pk_bf16_f32 v40, v208, v209
    v_cvt_pk_bf16_f32 v41, v210, v211
    v_mfma_f32_16x16x32_bf16 v[204:207], v[32:35], v[124:127], 0
    v_cvt_pk_bf16_f32 v42, v212, v213
    v_cvt_pk_bf16_f32 v43, v214, v215
    s_nop 1
    v_mfma_f32_16x16x32_bf16 v[208:211], v[40:43], v[132:135], 0
    v_cvt_pk_bf16_f32 v48, v216, v217
    v_cvt_pk_bf16_f32 v49, v218, v219
    v_mfma_f32_16x16x32_bf16 v[212:215], v[40:43], v[130:133], 0
    v_cvt_pk_bf16_f32 v50, v220, v221
    v_cvt_pk_bf16_f32 v51, v222, v223
    s_nop 1
    v_mfma_f32_16x16x32_bf16 v[216:219], v[48:51], v[138:141], 0
    v_cvt_pk_bf16_f32 v56, v224, v225
    v_cvt_pk_bf16_f32 v57, v226, v227
    v_mfma_f32_16x16x32_bf16 v[220:223], v[48:51], v[136:139], 0
    v_cvt_pk_bf16_f32 v58, v228, v229
    v_cvt_pk_bf16_f32 v59, v230, v231
    s_nop 1
    v_mfma_f32_16x16x32_bf16 v[224:227], v[56:59], v[144:147], 0
    v_mfma_f32_16x16x32_bf16 v[228:231], v[56:59], v[142:145], 0
    v_cvt_pk_bf16_f32 v80, v200, v208
    v_cvt_pk_bf16_f32 v82, v204, v212
    v_cvt_pk_bf16_f32 v84, v201, v209
    v_cvt_pk_bf16_f32 v86, v205, v213
    v_cvt_pk_bf16_f32 v88, v202, v210
    v_cvt_pk_bf16_f32 v90, v206, v214
    v_cvt_pk_bf16_f32 v92, v203, v211
    v_cvt_pk_bf16_f32 v94, v207, v215
    v_cvt_pk_bf16_f32 v81, v216, v224
    v_cvt_pk_bf16_f32 v83, v220, v228
    ds_write_b128 v24, v[80:83] offset:0
    v_cvt_pk_bf16_f32 v85, v217, v225
    v_cvt_pk_bf16_f32 v87, v221, v229
    ds_write_b128 v24, v[84:87] offset:2048
    v_cvt_pk_bf16_f32 v89, v218, v226
    v_cvt_pk_bf16_f32 v91, v222, v230
    ds_write_b128 v24, v[88:91] offset:4096
    v_cvt_pk_bf16_f32 v93, v219, v227
    v_cvt_pk_bf16_f32 v95, v223, v231
    ds_write_b128 v24, v[92:95] offset:6144
    s_branch K1_J1
K1_T7:
    s_waitcnt vmcnt(11) lgkmcnt(0)
    s_barrier
    ds_write_b128 v24, v[96:99] offset:0
    ds_write_b128 v24, v[96:99] offset:2048
    ds_write_b128 v24, v[96:99] offset:4096
    ds_write_b128 v24, v[96:99] offset:6144
    s_cmp_lg_u32 s2, 0
    s_cbranch_scc1 K1_RP
    v_mov_b32 v27, 0x7fff0000
    v_mul_u32_u24 v28, 448, v3
    v_lshl_add_u32 v28, v2, 2, v28
    v_cmp_gt_u32 vcc, 12, v2
    v_add_u32 v29, 64, v28
    s_nop 0
    v_cndmask_b32 v29, v27, v29, vcc
    v_cndmask_b32 v27, 1, 0, vcc
    v_cvt_f32_u32 v6, v2
    v_lshlrev_b32 v7, 2, v3
    v_cvt_f32_u32 v7, v7
    v_mul_f32 v4, 0x3d800000, v6
    v_mul_f32 v5, v4, v7
    v_cos_f32 v64, v5
    v_sin_f32 v68, v5
    v_add_f32 v5, v5, v4
    v_cos_f32 v65, v5
    v_sin_f32 v69, v5
    v_add_f32 v5, v5, v4
    v_cos_f32 v66, v5
    v_sin_f32 v70, v5
    v_add_f32 v5, v5, v4
    v_cos_f32 v67, v5
    v_sin_f32 v71, v5
    v_mul_f32 v4, 0x3b124925, v6
    v_mul_f32 v5, v4, v7
    v_mul_f32 v6, 0x41500000, v4
    v_cos_f32 v72, v5
    v_sin_f32 v76, v5
    v_add_f32 v5, v5, v4
    v_cos_f32 v73, v5
    v_sin_f32 v77, v5
    v_add_f32 v5, v5, v4
    v_cos_f32 v74, v5
    v_sin_f32 v78, v5
    v_add_f32 v5, v5, v4
    v_cos_f32 v75, v5
    v_sin_f32 v79, v5
    v_add_f32 v5, v5, v6
    v_cos_f32 v80, v5
    v_sin_f32 v84, v5
    v_add_f32 v5, v5, v4
    v_cos_f32 v81, v5
    v_sin_f32 v85, v5
    v_add_f32 v5, v5, v4
    v_cos_f32 v82, v5
    v_sin_f32 v86, v5
    v_add_f32 v5, v5, v4
    v_cos_f32 v83, v5
    v_sin_f32 v87, v5
    v_add_f32 v5, v5, v6
    s_branch K1_RP
K1_W7:
    v_mov_b32 v42, 112640
    v_add_u32 v41, 112704, v1
    v_mov_b32 v208, 1
    v_mov_b32 v209, 1
    v_mov_b32 v210, 1
    v_mov_b32 v211, 1
    s_mov_b32 s90, 0
    s_mul_i32 s64, s56, 7
    s_add_u32 s64, s64, s19
    s_sub_u32 s64, s64, 57344
    s_add_u32 s65, s64, 8192
    s_add_u32 s66, s64, 16384
    s_add_u32 s67, s64, 20480
    v_lshlrev_b32 v40, 7, v0
    s_and_b32 s58, s2, 31
    s_lshl_b32 s58, 1, s58
    s_mov_b32 exec_lo, s58
    s_mov_b32 exec_hi, 0
    s_bfe_u32 s59, s2, 0x10005
    s_mul_i32 s59, s59, 7168
    s_add_u32 s59, s59, s52
    s_cmp_eq_u32 s59, s52
    s_cselect_b64 vcc, -1, 0
    s_waitcnt vmcnt(0)
    v_cndmask_b32 v142, v133, v129, vcc
K1_C0:
    buffer_load_dword v134, v1, s[12:15], s59 offen offset:2560 sc1
    s_add_u32 s90, s90, 1
    s_cmp_gt_u32 s90, 10
    s_cbranch_scc1 K1_C1
    s_waitcnt vmcnt(0)
    v_cmp_eq_u32 vcc, v134, v142
    s_nop 1
    s_cbranch_vccnz K1_C0
K1_C1:
    s_mov_b64 exec, -1
    s_mov_b32 s90, 0
K1_M0:
    buffer_load_dwordx4 v[172:175], v1, s[12:15], s52 offen offset:0 sc1
    buffer_load_dwordx4 v[176:179], v1, s[12:15], s52 offen offset:768 sc1
    buffer_load_dwordx4 v[180:183], v1, s[12:15], s52 offen offset:1792 sc1
    buffer_load_dwordx4 v[184:187], v1, s[12:15], s52 offen offset:2560 sc1
    buffer_load_dwordx4 v[188:191], v1, s[12:15], s53 offen offset:0 sc1
    buffer_load_dwordx4 v[192:195], v1, s[12:15], s53 offen offset:768 sc1
    buffer_load_dwordx4 v[196:199], v1, s[12:15], s53 offen offset:1792 sc1
    buffer_load_dwordx4 v[200:203], v1, s[12:15], s53 offen offset:2560 sc1
    s_add_u32 s90, s90, 1
    s_cmp_gt_u32 s90, 10
    s_cbranch_scc1 K1_MS
    s_waitcnt vmcnt(0)
    v_xor_b32 v134, v126, v172
    v_xor_b32 v135, v127, v176
    v_xor_b32 v136, v128, v180
    v_xor_b32 v137, v129, v184
    v_xor_b32 v138, v130, v188
    v_xor_b32 v139, v131, v192
    v_xor_b32 v140, v132, v196
    v_xor_b32 v141, v133, v200
    v_and_b32 v134, v134, v138
    v_and_b32 v135, v135, v139
    v_and_b32 v136, v136, v140
    v_and_b32 v137, v137, v141
    v_and_b32 v134, v134, v136
    v_and_b32 v135, v135, v137
    v_and_b32 v134, v134, v135
    v_and_b32 v134, 1, v134
    v_cmp_ne_u32 vcc, 1, v134
    s_nop 1
    s_cbranch_vccnz K1_M0
K1_M1:
    v_and_b32 v172, -2, v172
    v_and_b32 v176, -2, v176
    v_and_b32 v180, -2, v180
    v_and_b32 v184, -2, v184
    v_and_b32 v188, -2, v188
    v_and_b32 v192, -2, v192
    v_and_b32 v196, -2, v196
    v_and_b32 v200, -2, v200
    v_pk_add_f32 v[172:173], v[172:173], v[188:189]
    v_pk_add_f32 v[174:175], v[174:175], v[190:191]
    v_pk_add_f32 v[176:177], v[176:177], v[192:193]
    v_pk_add_f32 v[178:179], v[178:179], v[194:195]
    v_pk_add_f32 v[180:181], v[180:181], v[196:197]
    v_pk_add_f32 v[182:183], v[182:183], v[198:199]
    v_pk_add_f32 v[184:185], v[184:185], v[200:201]
    v_pk_add_f32 v[186:187], v[186:187], v[202:203]
    v_cvt_pk_bf16_f32 v188, v172, v173
    v_cvt_pk_bf16_f32 v189, v174, v175
    v_cvt_pk_bf16_f32 v190, v176, v177
    v_cvt_pk_bf16_f32 v191, v178, v179
    v_cvt_pk_bf16_f32 v192, v180, v181
    v_cvt_pk_bf16_f32 v193, v182, v183
    v_cvt_pk_bf16_f32 v194, v184, v185
    v_cvt_pk_bf16_f32 v195, v186, v187
    v_lshlrev_b32 v172, 16, v188
    v_and_b32 v173, 0xffff0000, v188
    v_lshlrev_b32 v174, 16, v189
    v_and_b32 v175, 0xffff0000, v189
    v_lshlrev_b32 v176, 16, v190
    v_and_b32 v177, 0xffff0000, v190
    v_lshlrev_b32 v178, 16, v191
    v_and_b32 v179, 0xffff0000, v191
    v_lshlrev_b32 v180, 16, v192
    v_and_b32 v181, 0xffff0000, v192
    v_lshlrev_b32 v182, 16, v193
    v_and_b32 v183, 0xffff0000, v193
    v_lshlrev_b32 v184, 16, v194
    v_and_b32 v185, 0xffff0000, v194
    v_lshlrev_b32 v186, 16, v195
    v_and_b32 v187, 0xffff0000, v195
    v_add_f32 v172, 1.0, v172
    v_add_f32 v173, 1.0, v173
    v_add_f32 v174, 1.0, v174
    v_add_f32 v175, 1.0, v175
    v_add_f32 v176, 1.0, v176
    v_add_f32 v177, 1.0, v177
    v_add_f32 v178, 1.0, v178
    v_add_f32 v179, 1.0, v179
    v_cvt_pk_bf16_f32 v188, v172, v173
    v_cvt_pk_bf16_f32 v189, v174, v175
    v_cvt_pk_bf16_f32 v190, v176, v177
    v_cvt_pk_bf16_f32 v191, v178, v179
    v_lshlrev_b32 v172, 16, v188
    v_and_b32 v173, 0xffff0000, v188
    v_lshlrev_b32 v174, 16, v189
    v_and_b32 v175, 0xffff0000, v189
    v_lshlrev_b32 v176, 16, v190
    v_and_b32 v177, 0xffff0000, v190
    v_lshlrev_b32 v178, 16, v191
    v_and_b32 v179, 0xffff0000, v191
    v_mul_f32 v180, 0x36124925, v180
    v_mul_f32 v181, 0x36124925, v181
    v_mul_f32 v182, 0x36124925, v182
    v_mul_f32 v183, 0x36124925, v183
    v_mul_f32 v184, 0x36124925, v184
    v_mul_f32 v185, 0x36124925, v185
    v_mul_f32 v186, 0x36124925, v186
    v_mul_f32 v187, 0x36124925, v187
    ds_write_b128 v41, v[172:175] offset:0
    ds_write_b128 v41, v[176:179] offset:768
    ds_write_b128 v41, v[180:183] offset:1792
    ds_write_b128 v41, v[184:187] offset:2560
    ds_write_b128 v42, v[208:211] offset:16
    s_mov_b32 s90, 0
K1_C2:
    buffer_load_dword v32, v144, s[12:15], s16 offen sc1
    s_add_u32 s90, s90, 1
    s_cmp_gt_u32 s90, 10
    s_cbranch_scc1 K1_C3
    s_waitcnt vmcnt(0)
    v_cmp_eq_u32 vcc, v143, v32
    s_nop 1
    s_cbranch_vccnz K1_C2
K1_C3:
    s_mov_b32 s90, 0
    s_cmp_lg_u32 s2, 0
    s_cbranch_scc1 K1_SG0
    buffer_load_dword v240, v28, s[12:15], s18 offen offset:0 sc1
    buffer_load_dword v241, v28, s[12:15], s18 offen offset:112 sc1
    buffer_load_dword v242, v28, s[12:15], s18 offen offset:224 sc1
    buffer_load_dword v243, v28, s[12:15], s18 offen offset:336 sc1
    buffer_load_dword v244, v29, s[12:15], s18 offen offset:0 sc1
    buffer_load_dword v245, v29, s[12:15], s18 offen offset:112 sc1
    buffer_load_dword v246, v29, s[12:15], s18 offen offset:224 sc1
    buffer_load_dword v247, v29, s[12:15], s18 offen offset:336 sc1
K1_SG0:
    buffer_load_dword v32, v43, s[12:15], s57 offen sc1
    buffer_load_dword v33, v43, s[12:15], s54 offen sc1
    buffer_load_dword v38, v40, s[12:15], s64 offen sc1
    buffer_load_dword v38, v40, s[12:15], s65 offen sc1
    buffer_load_dword v38, v40, s[12:15], s66 offen sc1
    buffer_load_dword v38, v40, s[12:15], s67 offen sc1
    s_waitcnt vmcnt(4)
K1_P0:
    v_cmp_eq_u32 s[58:59], v124, v32
    v_cmp_eq_u32 vcc, v125, v33
    s_nop 0
    v_mov_b32 v204, s58
    v_mov_b32 v205, s59
    v_mov_b32 v206, vcc_lo
    v_mov_b32 v207, vcc_hi
    s_or_b64 s[58:59], s[58:59], vcc
    ds_write_b128 v42, v[204:207]
    s_cbranch_scc0 K1_P1
    buffer_load_dword v32, v43, s[12:15], s57 offen sc1
    buffer_load_dword v33, v43, s[12:15], s54 offen sc1
    s_add_u32 s90, s90, 1
    s_cmp_gt_u32 s90, 10
    s_waitcnt vmcnt(0)
    s_cbranch_scc0 K1_P0
    s_mov_b32 s90, 0
K1_PWC_L:
    buffer_load_dword v134, off, s[72:75], 0 sc1
    s_add_u32 s90, s90, 1
    s_cmp_gt_u32 s90, 200000
    s_cbranch_scc1 K1_PWC_E
    s_waitcnt vmcnt(0)
    v_cmp_ne_u32 vcc, 1, v134
    s_nop 1
    s_cbranch_vccnz K1_PWC_L
K1_PWC_E:
    v_min_u32 v136, 63, v0
    v_lshlrev_b32 v136, 7, v136
    s_mov_b32 s88, 0x1f0000
    s_mov_b32 s89, 0x1f2000
    s_mov_b32 s90, 0
K1_PW_L:
    buffer_load_dword v134, v136, s[12:15], s88 offen sc1
    buffer_load_dword v135, v136, s[12:15], s89 offen sc1
    s_add_u32 s90, s90, 1
    s_cmp_gt_u32 s90, 200000
    s_cbranch_scc1 K1_PW_E
    s_waitcnt vmcnt(0)
    v_and_b32 v134, v134, v135
    v_cmp_ne_u32 vcc, 1, v134
    s_nop 1
    s_cbranch_vccnz K1_PW_L
K1_PW_E:
    v_mov_b32 v204, 0
    v_mov_b32 v205, 0
    v_mov_b32 v206, 0
    v_mov_b32 v207, 0
    ds_write_b128 v42, v[204:207]
K1_P1:
    s_waitcnt vmcnt(0)
    s_cmp_lg_u32 s2, 0
    s_cbranch_scc1 K1_J1
    v_xor_b32 v32, v232, v240
    v_xor_b32 v33, v233, v241
    v_xor_b32 v34, v234, v242
    v_xor_b32 v35, v235, v243
    v_xor_b32 v36, v236, v244
    v_xor_b32 v37, v237, v245
    v_xor_b32 v38, v238, v246
    v_xor_b32 v39, v239, v247
    v_and_b32 v32, v32, v33
    v_and_b32 v34, v34, v35
    v_and_b32 v36, v36, v37
    v_and_b32 v38, v38, v39
    v_and_b32 v32, v32, v34
    v_and_or_b32 v36, v36, v38, v27
    v_and_b32 v32, v32, v36
    v_and_b32 v32, 1, v32
    v_cmp_ne_u32 vcc, 1, v32
    v_cvt_pk_bf16_f32 v48, v64, v65
    v_cvt_pk_bf16_f32 v52, -v68, -v69
    v_mov_b32 v42, 0
    v_mov_b32 v46, 0
    v_mov_b32 v50, 0
    v_mov_b32 v54, 0
    v_cvt_pk_bf16_f32 v49, v66, v67
    v_cvt_pk_bf16_f32 v53, -v70, -v71
    v_mov_b32 v43, 0
    v_mov_b32 v47, 0
    v_mov_b32 v51, 0
    v_mov_b32 v55, 0
    s_cbranch_vccnz K1_SG4
K1_SG2:
    v_cvt_pk_bf16_f32 v40, v240, v241
    v_cvt_pk_bf16_f32 v41, v242, v243
    v_cvt_pk_bf16_f32 v44, v244, v245
    v_cvt_pk_bf16_f32 v45, v246, v247
    v_mfma_f32_16x16x32_bf16 v[200:203], v[40:43], v[48:51], 0
    v_mfma_f32_16x16x32_bf16 v[204:207], v[40:43], v[52:55], 0
    v_mfma_f32_16x16x32_bf16 v[208:211], v[44:47], v[48:51], 0
    v_mfma_f32_16x16x32_bf16 v[212:215], v[44:47], v[52:55], 0
    s_nop 5
    v_mul_f32 v216, v204, v76
    v_mul_f32 v220, v200, v76
    v_fma_f32 v216, v200, v72, v216
    v_fma_f32 v220, v204, v72, -v220
    v_mul_f32 v217, v205, v77
    v_mul_f32 v221, v201, v77
    v_fma_f32 v217, v201, v73, v217
    v_fma_f32 v221, v205, v73, -v221
    v_mul_f32 v218, v206, v78
    v_mul_f32 v222, v202, v78
    v_fma_f32 v218, v202, v74, v218
    v_fma_f32 v222, v206, v74, -v222
    v_mul_f32 v219, v207, v79
    v_mul_f32 v223, v203, v79
    v_fma_f32 v219, v203, v75, v219
    v_fma_f32 v223, v207, v75, -v223
    v_cvt_pk_bf16_f32 v32, v216, v217
    v_cvt_pk_bf16_f32 v33, v218, v219
    v_cvt_pk_bf16_f32 v34, v220, v221
    v_cvt_pk_bf16_f32 v35, v222, v223
    v_mul_f32 v224, v212, v84
    v_mul_f32 v228, v208, v84
    v_fma_f32 v224, v208, v80, v224
    v_fma_f32 v228, v212, v80, -v228
    v_mul_f32 v225, v213, v85
    v_mul_f32 v229, v209, v85
    v_fma_f32 v225, v209, v81, v225
    v_fma_f32 v229, v213, v81, -v229
    v_mul_f32 v226, v214, v86
    v_mul_f32 v230, v210, v86
    v_fma_f32 v226, v210, v82, v226
    v_fma_f32 v230, v214, v82, -v230
    v_mul_f32 v227, v215, v87
    v_mul_f32 v231, v211, v87
    v_fma_f32 v227, v211, v83, v227
    v_fma_f32 v231, v215, v83, -v231
    v_cvt_pk_bf16_f32 v36, v224, v225
    v_cvt_pk_bf16_f32 v37, v226, v227
    v_cvt_pk_bf16_f32 v38, v228, v229
    v_cvt_pk_bf16_f32 v39, v230, v231
    s_waitcnt lgkmcnt(0)
    v_mfma_f32_16x16x32_bf16 v[200:203], v[150:153], v[32:35], 0
    v_mfma_f32_16x16x32_bf16 v[204:207], v[148:151], v[32:35], 0
    v_mfma_f32_16x16x32_bf16 v[208:211], v[162:165], v[32:35], 0
    v_mfma_f32_16x16x32_bf16 v[212:215], v[160:163], v[32:35], 0
    v_mfma_f32_16x16x32_bf16 v[200:203], v[156:159], v[36:39], v[200:203]
    v_mfma_f32_16x16x32_bf16 v[204:207], v[154:157], v[36:39], v[204:207]
    v_mfma_f32_16x16x32_bf16 v[208:211], v[168:171], v[36:39], v[208:211]
    v_mfma_f32_16x16x32_bf16 v[212:215], v[166:169], v[36:39], v[212:215]
    s_nop 4
    ds_write_b128 v30, v[200:203] offset:0
    ds_write_b128 v30, v[204:207] offset:1024
    ds_write_b128 v30, v[208:211] offset:2048
    ds_write_b128 v30, v[212:215] offset:3072
K1_J1:
    s_mov_b64 vcc, 0
K1_J2:
    s_cmp_eq_u32 s55, 0
    s_waitcnt lgkmcnt(0)
    s_barrier
    ds_read_b128 v[32:35], v25 offset:0
    ds_read_b128 v[36:39], v113 offset:0
    ds_read_b128 v[40:43], v25 offset:2048
    ds_read_b128 v[44:47], v113 offset:2048
    s_cbranch_scc1 K1_B0
    s_waitcnt lgkmcnt(3)
    v_mfma_f32_16x16x32_bf16 v[200:203], v[150:153], v[32:35], 0
    v_mfma_f32_16x16x32_bf16 v[204:207], v[148:151], v[32:35], 0
    v_mfma_f32_16x16x32_bf16 v[208:211], v[162:165], v[32:35], 0
    v_mfma_f32_16x16x32_bf16 v[212:215], v[160:163], v[32:35], 0
K1_B1:
    s_waitcnt lgkmcnt(2)
    v_mfma_f32_16x16x32_bf16 v[200:203], v[156:159], v[36:39], v[200:203]
    v_mfma_f32_16x16x32_bf16 v[204:207], v[154:157], v[36:39], v[204:207]
    v_mfma_f32_16x16x32_bf16 v[208:211], v[168:171], v[36:39], v[208:211]
    v_mfma_f32_16x16x32_bf16 v[212:215], v[166:169], v[36:39], v[212:215]
    s_waitcnt lgkmcnt(0)
    v_mfma_f32_16x16x32_bf16 v[216:219], v[150:153], v[40:43], 0
    v_mfma_f32_16x16x32_bf16 v[220:223], v[148:151], v[40:43], 0
    v_mfma_f32_16x16x32_bf16 v[224:227], v[162:165], v[40:43], 0
    s_nop 1
    v_mul_f32 v64, v204, v8
    v_mul_f32 v68, v200, v8
    v_mfma_f32_16x16x32_bf16 v[228:231], v[160:163], v[40:43], 0
    v_mul_f32 v65, v205, v9
    v_mul_f32 v69, v201, v9
    v_mfma_f32_16x16x32_bf16 v[216:219], v[156:159], v[44:47], v[216:219]
    v_mul_f32 v66, v206, v10
    v_mul_f32 v70, v202, v10
    v_mfma_f32_16x16x32_bf16 v[220:223], v[154:157], v[44:47], v[220:223]
    v_mul_f32 v67, v207, v11
    v_mul_f32 v71, v203, v11
    v_mfma_f32_16x16x32_bf16 v[224:227], v[168:171], v[44:47], v[224:227]
    v_fma_f32 v64, v200, v96, -v64
    v_fma_f32 v68, -v204, v96, -v68
    v_mfma_f32_16x16x32_bf16 v[228:231], v[166:169], v[44:47], v[228:231]
    v_fma_f32 v65, v201, v97, -v65
    v_fma_f32 v69, -v205, v97, -v69
    v_fma_f32 v66, v202, v98, -v66
    v_fma_f32 v70, -v206, v98, -v70
    v_fma_f32 v67, v203, v99, -v67
    v_fma_f32 v71, -v207, v99, -v71
    v_cvt_pk_bf16_f32 v48, v64, v65
    v_cvt_pk_bf16_f32 v49, v66, v67
    v_cvt_pk_bf16_f32 v50, v68, v69
    v_cvt_pk_bf16_f32 v51, v70, v71
    v_mul_f32 v72, v212, v12
    v_mul_f32 v76, v208, v12
    v_mul_f32 v73, v213, v13
    v_mul_f32 v77, v209, v13
    v_mul_f32 v74, v214, v14
    v_mul_f32 v78, v210, v14
    v_mul_f32 v75, v215, v15
    v_mul_f32 v79, v211, v15
    v_fma_f32 v72, v208, v100, -v72
    v_fma_f32 v76, -v212, v100, -v76
    v_fma_f32 v73, v209, v101, -v73
    v_fma_f32 v77, -v213, v101, -v77
    v_fma_f32 v74, v210, v102, -v74
    v_fma_f32 v78, -v214, v102, -v78
    v_fma_f32 v75, v211, v103, -v75
    v_fma_f32 v79, -v215, v103, -v79
    v_cvt_pk_bf16_f32 v52, v72, v73
    v_cvt_pk_bf16_f32 v53, v74, v75
    v_cvt_pk_bf16_f32 v54, v76, v77
    v_cvt_pk_bf16_f32 v55, v78, v79
    v_pk_mul_f32 v[80:81], v[220:221], v[16:17]
    v_pk_mul_f32 v[84:85], v[216:217], v[16:17]
    v_pk_fma_f32 v[80:81], v[216:217], v[104:105], v[80:81] neg_lo:[0,0,1] neg_hi:[0,0,1]
    v_pk_fma_f32 v[84:85], v[220:221], v[104:105], v[84:85] neg_lo:[1,0,1] neg_hi:[1,0,1]
    v_pk_mul_f32 v[82:83], v[222:223], v[18:19]
    v_pk_mul_f32 v[86:87], v[218:219], v[18:19]
    v_pk_fma_f32 v[82:83], v[218:219], v[106:107], v[82:83] neg_lo:[0,0,1] neg_hi:[0,0,1]
    v_pk_fma_f32 v[86:87], v[222:223], v[106:107], v[86:87] neg_lo:[1,0,1] neg_hi:[1,0,1]
    v_pk_mul_f32 v[88:89], v[228:229], v[20:21]
    v_pk_mul_f32 v[92:93], v[224:225], v[20:21]
    v_pk_fma_f32 v[88:89], v[224:225], v[108:109], v[88:89] neg_lo:[0,0,1] neg_hi:[0,0,1]
    v_pk_fma_f32 v[92:93], v[228:229], v[108:109], v[92:93] neg_lo:[1,0,1] neg_hi:[1,0,1]
    v_pk_mul_f32 v[90:91], v[230:231], v[22:23]
    v_pk_mul_f32 v[94:95], v[226:227], v[22:23]
    v_pk_fma_f32 v[90:91], v[226:227], v[110:111], v[90:91] neg_lo:[0,0,1] neg_hi:[0,0,1]
    v_pk_fma_f32 v[94:95], v[230:231], v[110:111], v[94:95] neg_lo:[1,0,1] neg_hi:[1,0,1]
    v_mfma_f32_16x16x32_bf16 v[200:203], v[48:51], v[150:153], 0
    v_cvt_pk_bf16_f32 v56, v80, v81
    v_mfma_f32_16x16x32_bf16 v[204:207], v[48:51], v[148:151], 0
    v_cvt_pk_bf16_f32 v57, v82, v83
    v_mfma_f32_16x16x32_bf16 v[208:211], v[48:51], v[162:165], 0
    v_cvt_pk_bf16_f32 v58, v84, v85
    v_mfma_f32_16x16x32_bf16 v[212:215], v[48:51], v[160:163], 0
    v_cvt_pk_bf16_f32 v59, v86, v87
    v_mfma_f32_16x16x32_bf16 v[200:203], v[52:55], v[156:159], v[200:203]
    v_cvt_pk_bf16_f32 v60, v88, v89
    v_mfma_f32_16x16x32_bf16 v[204:207], v[52:55], v[154:157], v[204:207]
    v_cvt_pk_bf16_f32 v61, v90, v91
    v_mfma_f32_16x16x32_bf16 v[208:211], v[52:55], v[168:171], v[208:211]
    v_cvt_pk_bf16_f32 v62, v92, v93
    v_mfma_f32_16x16x32_bf16 v[212:215], v[52:55], v[166:169], v[212:215]
    v_cvt_pk_bf16_f32 v63, v94, v95
    v_mfma_f32_16x16x32_bf16 v[216:219], v[56:59], v[150:153], 0
    v_mfma_f32_16x16x32_bf16 v[220:223], v[56:59], v[148:151], 0
    v_mfma_f32_16x16x32_bf16 v[224:227], v[56:59], v[162:165], 0
    v_mfma_f32_16x16x32_bf16 v[228:231], v[56:59], v[160:163], 0
    v_cvt_pk_bf16_f32 v32, v200, v201
    v_cvt_pk_bf16_f32 v33, v202, v203
    v_mfma_f32_16x16x32_bf16 v[216:219], v[60:63], v[156:159], v[216:219]
    v_cvt_pk_bf16_f32 v34, v204, v205
    v_cvt_pk_bf16_f32 v35, v206, v207
    v_mfma_f32_16x16x32_bf16 v[220:223], v[60:63], v[154:157], v[220:223]
    ds_write_b128 v26, v[32:35] offset:0
    v_cvt_pk_bf16_f32 v36, v208, v209
    v_mfma_f32_16x16x32_bf16 v[224:227], v[60:63], v[168:171], v[224:227]
    v_cvt_pk_bf16_f32 v37, v210, v211
    v_cvt_pk_bf16_f32 v38, v212, v213
    v_mfma_f32_16x16x32_bf16 v[228:231], v[60:63], v[166:169], v[228:231]
    v_cvt_pk_bf16_f32 v39, v214, v215
    ds_write_b128 v26, v[36:39] offset:16640
    v_cvt_pk_bf16_f32 v40, v216, v217
    v_cvt_pk_bf16_f32 v41, v218, v219
    v_cvt_pk_bf16_f32 v42, v220, v221
    v_cvt_pk_bf16_f32 v43, v222, v223
    ds_write_b128 v26, v[40:43] offset:64
    v_cvt_pk_bf16_f32 v44, v224, v225
    v_cvt_pk_bf16_f32 v45, v226, v227
    v_cvt_pk_bf16_f32 v46, v228, v229
    v_cvt_pk_bf16_f32 v47, v230, v231
    ds_write_b128 v26, v[44:47] offset:16704
    s_waitcnt lgkmcnt(0)
    s_barrier
    s_cmp_eq_u32 s3, 7
    s_cbranch_scc1 K01_END
    ds_read_b128 v[48:51], v29 offset:0
    ds_read_b128 v[52:55], v29 offset:1040
    ds_read_b128 v[56:59], v29 offset:2080
    ds_read_b128 v[60:63], v29 offset:3120
    s_waitcnt lgkmcnt(3)
    v_mfma_f32_16x16x32_bf16 v[200:203], v[48:51], v[174:177], 0
    v_mfma_f32_16x16x32_bf16 v[204:207], v[48:51], v[172:175], 0
    s_waitcnt lgkmcnt(2)
    v_mfma_f32_16x16x32_bf16 v[208:211], v[52:55], v[180:183], 0
    v_mfma_f32_16x16x32_bf16 v[212:215], v[52:55], v[178:181], 0
    s_waitcnt lgkmcnt(1)
    v_mfma_f32_16x16x32_bf16 v[216:219], v[56:59], v[186:189], 0
    v_mfma_f32_16x16x32_bf16 v[220:223], v[56:59], v[184:187], 0
    s_waitcnt lgkmcnt(0)
    v_mfma_f32_16x16x32_bf16 v[224:227], v[60:63], v[192:195], 0
    v_mfma_f32_16x16x32_bf16 v[228:231], v[60:63], v[190:193], 0
    v_cvt_pk_bf16_f32 v32, v200, v201
    v_cvt_pk_bf16_f32 v33, v202, v203
    v_cvt_pk_bf16_f32 v34, v204, v205
    v_cvt_pk_bf16_f32 v35, v206, v207
    s_nop 1
    v_mfma_f32_16x16x32_bf16 v[64:67], v[118:121], v[32:35], 0
    v_cvt_pk_bf16_f32 v36, v208, v209
    v_cvt_pk_bf16_f32 v37, v210, v211
    v_mfma_f32_16x16x32_bf16 v[68:71], v[116:119], v[32:35], 0
    v_cvt_pk_bf16_f32 v38, v212, v213
    v_cvt_pk_bf16_f32 v39, v214, v215
    s_nop 1
    v_mfma_f32_16x16x32_bf16 v[72:75], v[118:121], v[36:39], 0
    v_cvt_pk_bf16_f32 v40, v216, v217
    v_cvt_pk_bf16_f32 v41, v218, v219
    v_mfma_f32_16x16x32_bf16 v[76:79], v[116:119], v[36:39], 0
    v_cvt_pk_bf16_f32 v42, v220, v221
    v_cvt_pk_bf16_f32 v43, v222, v223
    s_nop 1
    v_mfma_f32_16x16x32_bf16 v[80:83], v[118:121], v[40:43], 0
    v_cvt_pk_bf16_f32 v44, v224, v225
    v_cvt_pk_bf16_f32 v45, v226, v227
    v_mfma_f32_16x16x32_bf16 v[84:87], v[116:119], v[40:43], 0
    v_cvt_pk_bf16_f32 v46, v228, v229
    v_cvt_pk_bf16_f32 v47, v230, v231
    s_nop 1
    v_mfma_f32_16x16x32_bf16 v[88:91], v[118:121], v[44:47], 0
    v_mfma_f32_16x16x32_bf16 v[92:95], v[116:119], v[44:47], 0
    s_nop 5
    s_cmp_eq_u32 s25, 0
    s_cbranch_scc1 K1_SHORT
    v_cvt_pk_bf16_f32 v48, v64, v72
    v_cvt_pk_bf16_f32 v49, v80, v88
    v_cvt_pk_bf16_f32 v50, v68, v76
    v_cvt_pk_bf16_f32 v51, v84, v92
    buffer_store_dwordx4 v[48:51], v27, s[12:15], s60 offen
    v_cvt_pk_bf16_f32 v52, v65, v73
    v_cvt_pk_bf16_f32 v53, v81, v89
    v_cvt_pk_bf16_f32 v54, v69, v77
    v_cvt_pk_bf16_f32 v55, v85, v93
    buffer_store_dwordx4 v[52:55], v27, s[12:15], s61 offen
    v_cvt_pk_bf16_f32 v56, v66, v74
    v_cvt_pk_bf16_f32 v57, v82, v90
    v_cvt_pk_bf16_f32 v58, v70, v78
    v_cvt_pk_bf16_f32 v59, v86, v94
    buffer_store_dwordx4 v[56:59], v27, s[12:15], s62 offen
    v_cvt_pk_bf16_f32 v60, v67, v75
    v_cvt_pk_bf16_f32 v61, v83, v91
    v_cvt_pk_bf16_f32 v62, v71, v79
    v_cvt_pk_bf16_f32 v63, v87, v95
    buffer_store_dwordx4 v[60:63], v27, s[12:15], s63 offen
    s_endpgm
K1_SHORT:
    s_lshr_b32 s24, s2, 3
    v_add_u32 v27, s24, v27
    v_cvt_pk_bf16_f32 v48, v64, v72
    v_cvt_pk_bf16_f32 v49, v80, v88
    buffer_store_dwordx2 v[48:49], v27, s[12:15], s60 offen
    v_cvt_pk_bf16_f32 v52, v65, v73
    v_cvt_pk_bf16_f32 v53, v81, v89
    buffer_store_dwordx2 v[52:53], v27, s[12:15], s61 offen
    v_cvt_pk_bf16_f32 v56, v66, v74
    v_cvt_pk_bf16_f32 v57, v82, v90
    buffer_store_dwordx2 v[56:57], v27, s[12:15], s62 offen
    v_cvt_pk_bf16_f32 v60, v67, v75
    v_cvt_pk_bf16_f32 v61, v83, v91
    buffer_store_dwordx2 v[60:61], v27, s[12:15], s63 offen
    s_endpgm
.p2align 7
K01_DX:
    s_cmp_lt_u32 s2, 241
    s_cbranch_scc1 K01_F
    s_cmp_ge_u32 s2, 256
    s_cbranch_scc1 K01_END
    s_load_dwordx4 s[68:71], s[0:1], 80
    s_load_dwordx4 s[32:35], s[0:1], 8
    s_load_dwordx2 s[6:7], s[0:1], 48
    s_lshr_b32 s3, s3, 6
    v_and_b32 v0, 63, v0
    v_lshlrev_b32 v1, 4, v0
    v_and_b32 v2, 15, v0
    v_lshrrev_b32 v3, 4, v0
K01_D:
    s_cmp_ge_u32 s2, 241
    s_cselect_b32 s19, 65, 0
    s_sub_u32 s19, s2, s19
    s_sub_u32 s19, s19, 170
    s_lshl_b32 s19, s19, 3
    s_add_u32 s19, s19, s3
    s_add_u32 s18, s19, 168
    s_add_u32 s17, s19, 336
    s_waitcnt lgkmcnt(0)
    s_mov_b32 s12, s70
    s_mov_b32 s13, s71
    s_mov_b32 s14, 0x10000000
    s_mov_b32 s15, 0x00020000
    s_mov_b32 s72, s68
    s_mov_b32 s73, s69
    s_mov_b32 s74, 0x100
    s_mov_b32 s75, 0x00020000
    s_lshl_b32 s16, s19, 10
    s_add_u32 s16, s16, 0x1e0000
    s_cmp_lt_u32 s19, 24
    s_cselect_b32 s20, 0, 0x7fff0000
    v_add_u32 v24, s20, v1
    v_mov_b32 v4, 0
    v_mov_b32 v5, 0
    v_mov_b32 v6, 0
    v_mov_b32 v7, 0
    buffer_store_dwordx4 v[4:7], v24, s[12:15], s16 offen sc1
    s_cmp_lg_u32 s19, 24
    s_cbranch_scc1 K01_D1
    v_lshlrev_b32 v24, 7, v0
    s_mov_b32 s16, 0x1f0000
    buffer_store_dword v4, v24, s[12:15], s16 offen sc1
    s_add_u32 s16, s16, 8192
    buffer_store_dword v4, v24, s[12:15], s16 offen sc1
    s_add_u32 s16, s16, 8192
    buffer_store_dword v4, v24, s[12:15], s16 offen sc1
    s_add_u32 s16, s16, 8192
    v_mov_b32 v5, 1
    v_mov_b32 v24, 0x7fff0000
    v_writelane_b32 v24, 0, 0
    s_waitcnt vmcnt(0)
    buffer_store_dword v5, v24, s[72:75], 0 offen sc1
K01_D1:
    s_mov_b32 s8, s6
    s_mov_b32 s9, s7
    s_cmp_lt_u32 s19, 392
    s_cselect_b32 s10, 0x188000, 0
    s_mov_b32 s11, 0x00020000
    s_cselect_b32 s23, 0, 0x7fff0000
    s_mul_i32 s20, s19, 1171
    s_lshr_b32 s20, s20, 13
    s_mul_i32 s21, s20, 7
    s_sub_u32 s21, s19, s21
    s_mul_i32 s22, s20, 28672
    s_lshl_b32 s19, s21, 7
    s_add_u32 s22, s22, s19
    s_lshl_b32 s19, s3, 12
    s_add_u32 s19, s19, 0
    s_mov_b32 m0, s19
    v_lshrrev_b32 v8, 3, v0
    v_mul_u32_u24 v8, 896, v8
    v_and_b32 v9, 7, v0
    v_lshl_add_u32 v8, v9, 4, v8
    buffer_load_dwordx4 v8, s[8:11], s22 offen nt lds
    s_add_u32 m0, m0, 1024
    s_add_u32 s22, s22, 7168
    buffer_load_dwordx4 v8, s[8:11], s22 offen nt lds
    s_add_u32 m0, m0, 1024
    s_add_u32 s22, s22, 7168
    buffer_load_dwordx4 v8, s[8:11], s22 offen nt lds
    s_add_u32 m0, m0, 1024
    s_add_u32 s22, s22, 7168
    buffer_load_dwordx4 v8, s[8:11], s22 offen nt lds
    v_lshrrev_b32 v9, 2, v2
    v_lshrrev_b32 v10, 5, v0
    v_lshl_add_u32 v9, v10, 2, v9
    v_lshlrev_b32 v9, 7, v9
    v_and_b32 v10, 1, v3
    v_lshl_add_u32 v9, v10, 5, v9
    v_and_b32 v10, 3, v0
    v_lshl_add_u32 v9, v10, 3, v9
    v_add_u32 v9, s19, v9
    v_add_u32 v10, s23, v1
    s_mul_i32 s21, s21, 112
    s_lshl_b32 s20, s20, 1
    s_add_u32 s20, s20, s21
    s_lshl_b32 s20, s20, 11
    s_add_u32 s20, s20, 0xa00000
    s_waitcnt vmcnt(0)
    s_mov_b32 s8, s6
    s_mov_b32 s9, s7
    s_cmp_lt_u32 s18, 392
    s_cselect_b32 s10, 0x188000, 0
    s_mov_b32 s11, 0x00020000
    s_cselect_b32 s27, 0, 0x7fff0000
    s_mul_i32 s24, s18, 1171
    s_lshr_b32 s24, s24, 13
    s_mul_i32 s25, s24, 7
    s_sub_u32 s25, s18, s25
    s_mul_i32 s26, s24, 28672
    s_lshl_b32 s18, s25, 7
    s_add_u32 s26, s26, s18
    s_lshl_b32 s18, s3, 12
    s_add_u32 s18, s18, 32768
    s_mov_b32 m0, s18
    v_lshrrev_b32 v12, 3, v0
    v_mul_u32_u24 v12, 896, v12
    v_and_b32 v13, 7, v0
    v_lshl_add_u32 v12, v13, 4, v12
    buffer_load_dwordx4 v12, s[8:11], s26 offen nt lds
    s_add_u32 m0, m0, 1024
    s_add_u32 s26, s26, 7168
    buffer_load_dwordx4 v12, s[8:11], s26 offen nt lds
    s_add_u32 m0, m0, 1024
    s_add_u32 s26, s26, 7168
    buffer_load_dwordx4 v12, s[8:11], s26 offen nt lds
    s_add_u32 m0, m0, 1024
    s_add_u32 s26, s26, 7168
    buffer_load_dwordx4 v12, s[8:11], s26 offen nt lds
    v_lshrrev_b32 v13, 2, v2
    v_lshrrev_b32 v14, 5, v0
    v_lshl_add_u32 v13, v14, 2, v13
    v_lshlrev_b32 v13, 7, v13
    v_and_b32 v14, 1, v3
    v_lshl_add_u32 v13, v14, 5, v13
    v_and_b32 v14, 3, v0
    v_lshl_add_u32 v13, v14, 3, v13
    v_add_u32 v13, s18, v13
    v_add_u32 v14, s27, v1
    s_mul_i32 s25, s25, 112
    s_lshl_b32 s24, s24, 1
    s_add_u32 s24, s24, s25
    s_lshl_b32 s24, s24, 11
    s_add_u32 s24, s24, 0xa00000
    ds_read_b64_tr_b16 v[32:33], v9 offset:0
    ds_read_b64_tr_b16 v[34:35], v9 offset:1024
    ds_read_b64_tr_b16 v[36:37], v9 offset:64
    ds_read_b64_tr_b16 v[38:39], v9 offset:1088
    ds_read_b64_tr_b16 v[40:41], v9 offset:2048
    ds_read_b64_tr_b16 v[42:43], v9 offset:3072
    ds_read_b64_tr_b16 v[44:45], v9 offset:2112
    ds_read_b64_tr_b16 v[46:47], v9 offset:3136
    s_waitcnt lgkmcnt(6)
    buffer_store_dwordx4 v[32:35], v10, s[12:15], s20 offen offset:0 sc1
    s_waitcnt lgkmcnt(4)
    buffer_store_dwordx4 v[36:39], v10, s[12:15], s20 offen offset:1024 sc1
    s_waitcnt lgkmcnt(2)
    buffer_store_dwordx4 v[40:43], v10, s[12:15], s20 offen offset:2048 sc1
    s_waitcnt lgkmcnt(0)
    buffer_store_dwordx4 v[44:47], v10, s[12:15], s20 offen offset:3072 sc1
    s_waitcnt vmcnt(4)
    ds_read_b64_tr_b16 v[48:49], v13 offset:0
    ds_read_b64_tr_b16 v[50:51], v13 offset:1024
    ds_read_b64_tr_b16 v[52:53], v13 offset:64
    ds_read_b64_tr_b16 v[54:55], v13 offset:1088
    ds_read_b64_tr_b16 v[56:57], v13 offset:2048
    ds_read_b64_tr_b16 v[58:59], v13 offset:3072
    ds_read_b64_tr_b16 v[60:61], v13 offset:2112
    ds_read_b64_tr_b16 v[62:63], v13 offset:3136
    s_waitcnt lgkmcnt(6)
    buffer_store_dwordx4 v[48:51], v14, s[12:15], s24 offen offset:0 sc1
    s_waitcnt lgkmcnt(4)
    buffer_store_dwordx4 v[52:55], v14, s[12:15], s24 offen offset:1024 sc1
    s_waitcnt lgkmcnt(2)
    buffer_store_dwordx4 v[56:59], v14, s[12:15], s24 offen offset:2048 sc1
    s_waitcnt lgkmcnt(0)
    buffer_store_dwordx4 v[60:63], v14, s[12:15], s24 offen offset:3072 sc1
K01_END:
    s_endpgm
K01_AW:
    s_mul_i32 s60, s2, 7
    s_add_u32 s60, s60, s3
    s_sub_u32 s60, s60, 504
    s_mov_b32 s8, s6
    s_mov_b32 s9, s7
    s_cmp_lt_u32 s60, 392
    s_cselect_b32 s10, 0x188000, 0
    s_mov_b32 s11, 0x00020000
    s_cselect_b32 s59, 0, 0x7fff0000
    s_mul_i32 s56, s60, 1171
    s_lshr_b32 s56, s56, 13
    s_mul_i32 s57, s56, 7
    s_sub_u32 s57, s60, s57
    s_mul_i32 s58, s56, 28672
    s_lshl_b32 s60, s57, 7
    s_add_u32 s58, s58, s60
    s_lshl_b32 s60, s3, 12
    s_add_u32 s60, s60, 61440
    s_mov_b32 m0, s60
    v_lshrrev_b32 v8, 3, v0
    v_mul_u32_u24 v8, 896, v8
    v_and_b32 v9, 7, v0
    v_lshl_add_u32 v8, v9, 4, v8
    buffer_load_dwordx4 v8, s[8:11], s58 offen nt lds
    s_add_u32 m0, m0, 1024
    s_add_u32 s58, s58, 7168
    buffer_load_dwordx4 v8, s[8:11], s58 offen nt lds
    s_add_u32 m0, m0, 1024
    s_add_u32 s58, s58, 7168
    buffer_load_dwordx4 v8, s[8:11], s58 offen nt lds
    s_add_u32 m0, m0, 1024
    s_add_u32 s58, s58, 7168
    buffer_load_dwordx4 v8, s[8:11], s58 offen nt lds
    v_lshrrev_b32 v9, 2, v2
    v_lshrrev_b32 v10, 5, v0
    v_lshl_add_u32 v9, v10, 2, v9
    v_lshlrev_b32 v9, 7, v9
    v_and_b32 v10, 1, v3
    v_lshl_add_u32 v9, v10, 5, v9
    v_and_b32 v10, 3, v0
    v_lshl_add_u32 v9, v10, 3, v9
    v_add_u32 v9, s60, v9
    v_add_u32 v10, s59, v1
    s_mul_i32 s57, s57, 112
    s_lshl_b32 s56, s56, 1
    s_add_u32 s56, s56, s57
    s_lshl_b32 s56, s56, 11
    s_add_u32 s56, s56, 0xa00000
    s_waitcnt lgkmcnt(0)
    buffer_store_dwordx4 v[188:191], v1, s[12:15], s54 offen offset:0 sc1
    buffer_store_dwordx4 v[192:195], v1, s[12:15], s54 offen offset:2048 sc1
    s_waitcnt vmcnt(2)
    ds_read_b64_tr_b16 v[32:33], v9 offset:0
    ds_read_b64_tr_b16 v[34:35], v9 offset:1024
    ds_read_b64_tr_b16 v[36:37], v9 offset:64
    ds_read_b64_tr_b16 v[38:39], v9 offset:1088
    ds_read_b64_tr_b16 v[40:41], v9 offset:2048
    ds_read_b64_tr_b16 v[42:43], v9 offset:3072
    ds_read_b64_tr_b16 v[44:45], v9 offset:2112
    ds_read_b64_tr_b16 v[46:47], v9 offset:3136
    s_waitcnt lgkmcnt(6)
    buffer_store_dwordx4 v[32:35], v10, s[12:15], s56 offen offset:0 sc1
    s_waitcnt lgkmcnt(4)
    buffer_store_dwordx4 v[36:39], v10, s[12:15], s56 offen offset:1024 sc1
    s_waitcnt lgkmcnt(2)
    buffer_store_dwordx4 v[40:43], v10, s[12:15], s56 offen offset:2048 sc1
    s_waitcnt lgkmcnt(0)
    buffer_store_dwordx4 v[44:47], v10, s[12:15], s56 offen offset:3072 sc1
    s_barrier
    s_endpgm
K01_AQS:
    s_mov_b64 exec, -1
    s_mov_b32 s90, 0
K01_QWC_L:
    buffer_load_dword v64, off, s[72:75], 0 sc1
    s_add_u32 s90, s90, 1
    s_cmp_gt_u32 s90, 200000
    s_cbranch_scc1 K01_QWC_E
    s_waitcnt vmcnt(0)
    v_cmp_ne_u32 vcc, 1, v64
    s_nop 1
    s_cbranch_vccnz K01_QWC_L
K01_QWC_E:
    v_min_u32 v66, 41, v0
    v_lshlrev_b32 v66, 7, v66
    s_mov_b32 s88, 0x1f4000
    s_mov_b32 s89, 0x1f2000
    s_mov_b32 s90, 0
K01_QW_L:
    buffer_load_dword v64, v66, s[12:15], s88 offen sc1
    s_add_u32 s90, s90, 1
    s_cmp_gt_u32 s90, 200000
    s_cbranch_scc1 K01_QW_E
    s_waitcnt vmcnt(0)
    v_cmp_ne_u32 vcc, 1, v64
    s_nop 1
    s_cbranch_vccnz K01_QW_L
K01_QW_E:
    s_mov_b32 exec_hi, 0x00ffffff
    buffer_load_dwordx4 v[32:35], v1, s[12:15], s30 offen offset:0 sc1
    buffer_load_dwordx4 v[36:39], v1, s[12:15], s30 offen offset:1792 sc1
    buffer_load_dwordx4 v[40:43], v1, s[12:15], s31 offen offset:0 sc1
    buffer_load_dwordx4 v[44:47], v1, s[12:15], s31 offen offset:1792 sc1
    s_waitcnt vmcnt(0)
    s_branch K01_AQ4
K1_MS:
    s_mov_b32 s90, 0
K1_MWC_L:
    buffer_load_dword v134, off, s[72:75], 0 sc1
    s_add_u32 s90, s90, 1
    s_cmp_gt_u32 s90, 200000
    s_cbranch_scc1 K1_MWC_E
    s_waitcnt vmcnt(0)
    v_cmp_ne_u32 vcc, 1, v134
    s_nop 1
    s_cbranch_vccnz K1_MWC_L
K1_MWC_E:
    v_min_u32 v136, 41, v0
    v_lshlrev_b32 v136, 7, v136
    s_mov_b32 s88, 0x1f4000
    s_mov_b32 s89, 0x1f2000
    s_mov_b32 s90, 0
K1_MW_L:
    buffer_load_dword v134, v136, s[12:15], s88 offen sc1
    s_add_u32 s90, s90, 1
    s_cmp_gt_u32 s90, 200000
    s_cbranch_scc1 K1_MW_E
    s_waitcnt vmcnt(0)
    v_cmp_ne_u32 vcc, 1, v134
    s_nop 1
    s_cbranch_vccnz K1_MW_L
K1_MW_E:
    buffer_load_dwordx4 v[172:175], v1, s[12:15], s52 offen offset:0 sc1
    buffer_load_dwordx4 v[176:179], v1, s[12:15], s52 offen offset:768 sc1
    buffer_load_dwordx4 v[180:183], v1, s[12:15], s52 offen offset:1792 sc1
    buffer_load_dwordx4 v[184:187], v1, s[12:15], s52 offen offset:2560 sc1
    buffer_load_dwordx4 v[188:191], v1, s[12:15], s53 offen offset:0 sc1
    buffer_load_dwordx4 v[192:195], v1, s[12:15], s53 offen offset:768 sc1
    buffer_load_dwordx4 v[196:199], v1, s[12:15], s53 offen offset:1792 sc1
    buffer_load_dwordx4 v[200:203], v1, s[12:15], s53 offen offset:2560 sc1
    s_waitcnt vmcnt(0)
    s_branch K1_M1
K1_SG4:
    s_mov_b32 s90, 0
K1_SG1:
    buffer_load_dword v240, v28, s[12:15], s18 offen offset:0 sc1
    buffer_load_dword v241, v28, s[12:15], s18 offen offset:112 sc1
    buffer_load_dword v242, v28, s[12:15], s18 offen offset:224 sc1
    buffer_load_dword v243, v28, s[12:15], s18 offen offset:336 sc1
    buffer_load_dword v244, v29, s[12:15], s18 offen offset:0 sc1
    buffer_load_dword v245, v29, s[12:15], s18 offen offset:112 sc1
    buffer_load_dword v246, v29, s[12:15], s18 offen offset:224 sc1
    buffer_load_dword v247, v29, s[12:15], s18 offen offset:336 sc1
    s_add_u32 s90, s90, 1
    s_cmp_gt_u32 s90, 10
    s_cbranch_scc1 K1_SGS
    s_waitcnt vmcnt(0)
    v_xor_b32 v32, v232, v240
    v_xor_b32 v33, v233, v241
    v_xor_b32 v34, v234, v242
    v_xor_b32 v35, v235, v243
    v_xor_b32 v36, v236, v244
    v_xor_b32 v37, v237, v245
    v_xor_b32 v38, v238, v246
    v_xor_b32 v39, v239, v247
    v_and_b32 v32, v32, v33
    v_and_b32 v34, v34, v35
    v_and_b32 v36, v36, v37
    v_and_b32 v38, v38, v39
    v_and_b32 v32, v32, v34
    v_and_or_b32 v36, v36, v38, v27
    v_and_b32 v32, v32, v36
    v_and_b32 v32, 1, v32
    v_cmp_ne_u32 vcc, 1, v32
    s_nop 1
    s_cbranch_vccnz K1_SG1
    s_branch K1_SG2
K1_SGS:
    s_mov_b32 s90, 0
K1_PSC_L:
    buffer_load_dword v134, off, s[72:75], 0 sc1
    s_add_u32 s90, s90, 1
    s_cmp_gt_u32 s90, 200000
    s_cbranch_scc1 K1_PSC_E
    s_waitcnt vmcnt(0)
    v_cmp_ne_u32 vcc, 1, v134
    s_nop 1
    s_cbranch_vccnz K1_PSC_L
K1_PSC_E:
    v_min_u32 v136, 41, v0
    v_lshlrev_b32 v136, 7, v136
    s_mov_b32 s88, 0x1f4000
    s_mov_b32 s89, 0x1f2000
    s_mov_b32 s90, 0
K1_PS_L:
    buffer_load_dword v134, v136, s[12:15], s88 offen sc1
    s_add_u32 s90, s90, 1
    s_cmp_gt_u32 s90, 200000
    s_cbranch_scc1 K1_PS_E
    s_waitcnt vmcnt(0)
    v_cmp_ne_u32 vcc, 1, v134
    s_nop 1
    s_cbranch_vccnz K1_PS_L
K1_PS_E:
    buffer_load_dword v240, v28, s[12:15], s18 offen offset:0 sc1
    buffer_load_dword v241, v28, s[12:15], s18 offen offset:112 sc1
    buffer_load_dword v242, v28, s[12:15], s18 offen offset:224 sc1
    buffer_load_dword v243, v28, s[12:15], s18 offen offset:336 sc1
    buffer_load_dword v244, v29, s[12:15], s18 offen offset:0 sc1
    buffer_load_dword v245, v29, s[12:15], s18 offen offset:112 sc1
    buffer_load_dword v246, v29, s[12:15], s18 offen offset:224 sc1
    buffer_load_dword v247, v29, s[12:15], s18 offen offset:336 sc1
    s_waitcnt vmcnt(0)
    s_branch K1_SG2
K1_B0:
    ds_read_b128 v[124:127], v30 offset:0
    ds_read_b128 v[128:131], v30 offset:1024
    ds_read_b128 v[132:135], v30 offset:2048
    ds_read_b128 v[136:139], v30 offset:3072
    s_waitcnt lgkmcnt(0)
    v_mfma_f32_16x16x32_bf16 v[200:203], v[150:153], v[32:35], v[124:127]
    v_mfma_f32_16x16x32_bf16 v[204:207], v[148:151], v[32:35], v[128:131]
    v_mfma_f32_16x16x32_bf16 v[208:211], v[162:165], v[32:35], v[132:135]
    v_mfma_f32_16x16x32_bf16 v[212:215], v[160:163], v[32:35], v[136:139]
    s_branch K1_B1
.globl k2_kernel
.p2align 8
.type k2_kernel,@function
k2_kernel:
    s_cmp_ge_u32 s2, 224
    s_cbranch_scc1 K2_END
    s_load_dwordx2 s[4:5], s[0:1], 88
    s_load_dwordx2 s[50:51], s[0:1], 72
    v_lshrrev_b32 v1, 6, v0
    v_and_b32 v0, 63, v0
    v_readfirstlane_b32 s3, v1
    v_lshlrev_b32 v1, 4, v0
    s_getpc_b64 s[6:7]
K2_PC:
    s_add_u32 s6, s6, k2_tbl-K2_PC
    s_addc_u32 s7, s7, 0
    s_mov_b32 s12, s6
    s_mov_b32 s13, s7
    s_mov_b32 s14, 0x4000
    s_mov_b32 s15, 0x00020000
    s_lshl_b32 s16, s3, 12
    s_add_u32 s17, s16, 117248
    s_mov_b32 m0, s17
    s_and_b32 s18, s2, 7
    s_lshr_b32 s19, s2, 3
    s_mul_i32 s20, s19, 37
    s_lshr_b32 s20, s20, 8
    s_mul_i32 s21, s20, 7
    s_sub_u32 s21, s19, s21
    s_lshr_b32 s22, s18, 1
    s_lshl_b32 s22, s22, 2
    s_add_u32 s20, s20, s22
    s_and_b32 s22, s18, 1
    s_mul_i32 s23, s22, 7
    s_add_u32 s23, s23, s21
    buffer_load_dwordx4 v1, s[12:15], s16 offen offset:0 lds
    buffer_load_dwordx4 v1, s[12:15], s16 offen offset:1024 lds
    buffer_load_dwordx4 v1, s[12:15], s16 offen offset:2048 lds
    buffer_load_dwordx4 v1, s[12:15], s16 offen offset:3072 lds
    s_and_b32 s40, s23, 3
    s_lshr_b32 s41, s23, 2
    s_cmp_eq_u32 s41, 3
    s_cselect_b32 s42, 1, 0
    s_lshl_b32 s40, s40, s42
    s_mul_i32 s40, s40, 28672
    s_lshl_b32 s41, s41, 13
    s_add_u32 s40, s40, s41
    s_cmp_ge_u32 s23, 12
    s_cselect_b32 s41, 7, 1
    s_lshl_b32 s41, s41, 12
    s_mul_i32 s26, s20, 114688
    s_add_u32 s40, s40, s26
    s_lshr_b32 s42, s3, 1
    s_mul_i32 s42, s42, s41
    s_and_b32 s43, s3, 1
    s_lshl_b32 s43, s43, 11
    s_add_u32 s42, s42, s43
    s_add_u32 s42, s42, s40
    s_mul_i32 s24, s20, 384
    s_add_u32 s24, s24, 0x400000
    s_add_u32 s42, s42, s24
    s_lshl_b32 s43, s3, 11
    s_add_u32 m0, s43, 8192
    s_lshl_b32 s43, s3, 10
    s_add_u32 s43, s43, s40
    s_add_u32 s43, s43, 0x200000
    s_add_u32 s44, s43, s41
    s_mul_i32 s25, s3, 28672
    s_add_u32 s26, s26, s25
    s_add_u32 s24, s26, s24
    s_add_u32 s26, s26, 0x200000
    s_waitcnt lgkmcnt(0)
    s_mov_b32 s8, s4
    s_mov_b32 s9, s5
    s_mov_b32 s10, 0x10000000
    s_mov_b32 s11, 0x00020000
    buffer_load_dwordx4 v1, s[8:11], s42 offen offset:0 lds
    buffer_load_dwordx4 v1, s[8:11], s42 offen offset:1024 lds
    buffer_load_dwordx4 a[248:251], v1, s[8:11], s43 offen
    buffer_load_dwordx4 a[252:255], v1, s[8:11], s44 offen
    v_and_b32 v2, 15, v0
    v_lshrrev_b32 v3, 4, v0
    s_lshl_b32 s28, s23, 2
    s_add_u32 s28, s28, s3
    s_mul_i32 s27, s28, 59392
    s_add_u32 s27, s27, 0x600000
    v_lshrrev_b32 v5, 2, v2
    v_cmp_eq_u32 vcc, v5, v3
    v_and_b32 v5, 1, v0
    v_lshlrev_b32 v5, 4, v5
    v_mov_b32 v6, 0x3f00
    v_lshlrev_b32 v6, v5, v6
    v_mov_b32 v7, 0
    v_cndmask_b32 v6, v7, v6, vcc
    v_mov_b32 v26, 0x7fff0000
    v_lshlrev_b32 v5, 3, v2
    v_cndmask_b32 v26, v26, v5, vcc
    v_and_b32 v5, 2, v0
    v_cmp_eq_u32 vcc, 0, v5
    s_nop 1
    v_cndmask_b32 v8, v7, v6, vcc
    v_cndmask_b32 v9, v6, v7, vcc
    v_mov_b32 v10, v8
    v_mov_b32 v11, v9
    v_lshlrev_b32 v5, 2, v8
    v_and_b32 v5, 0x80008000, v5
    v_or_b32 v12, v5, v8
    v_lshlrev_b32 v5, 2, v9
    v_and_b32 v5, 0x80008000, v5
    v_or_b32 v13, v5, v9
    v_lshrrev_b32 v33, 3, v0
    v_lshlrev_b32 v33, 6, v33
    v_and_b32 v5, 3, v0
    v_lshl_add_u32 v33, v5, 4, v33
    v_bfe_u32 v5, v0, 2, 1
    v_lshl_add_u32 v33, v5, 3, v33
    v_add_u32 v4, s25, v33
    v_add_u32 v23, 117248, v1
    v_add_u32 v24, s17, v1
    v_lshlrev_b32 v5, 4, v2
    v_lshl_add_u32 v25, v3, 11, v5
    v_add_u32 v14, s25, v25
    v_lshrrev_b32 v6, 1, v3
    v_lshl_add_u32 v15, v6, 11, v5
    v_and_b32 v6, 1, v3
    v_lshl_add_u32 v15, v6, 3, v15
    v_add_u32 v15, s25, v15
    v_mov_b32 v28, 0x3f803f80
    v_mov_b32 v29, 0x3f803f80
    v_mov_b32 v30, 0x3f803f80
    v_mov_b32 v31, 0x3f803f80
    s_lshl_b32 s45, s20, 4
    s_add_u32 s45, s45, s23
    s_lshl_b32 s48, s45, 10
    s_lshl_b32 s45, s45, 13
    s_lshl_b32 s29, s3, 8
    s_add_u32 s45, s45, s29
    s_add_u32 s45, s45, 0x1a00000
    s_lshl_b32 s29, s3, 7
    s_add_u32 s48, s48, s29
    s_add_u32 s48, s48, 0x1300000
    s_mov_b32 s52, 0xaaaaaaaa
    s_mov_b32 s53, 0xaaaaaaaa
    s_mov_b32 s54, 0xcccccccc
    s_mov_b32 s55, 0xcccccccc
    s_add_u32 m0, s25, 24576
    s_add_u32 s46, s24, 24576
    s_add_u32 s47, s26, 24576
    buffer_load_dwordx4 v1, s[8:11], s46 offen offset:0 lds
    buffer_load_dwordx4 v1, s[8:11], s46 offen offset:1024 lds
    buffer_load_dwordx4 v1, s[8:11], s46 offen offset:2048 lds
    buffer_load_dwordx4 v1, s[8:11], s46 offen offset:3072 lds
    buffer_load_dwordx4 a[200:203], v1, s[8:11], s47 offen offset:0
    buffer_load_dwordx4 a[204:207], v1, s[8:11], s47 offen offset:1024
    buffer_load_dwordx4 a[208:211], v1, s[8:11], s47 offen offset:2048
    buffer_load_dwordx4 a[212:215], v1, s[8:11], s47 offen offset:3072
    s_waitcnt vmcnt(12)
    s_barrier
    ds_read_b128 v[144:147], v24 offset:0
    ds_read_b128 v[148:151], v24 offset:1024
    ds_read_b128 v[152:155], v24 offset:2048
    ds_read_b128 v[156:159], v24 offset:3072
    ds_read_b128 v[64:67], v23 offset:0
    ds_read_b128 v[68:71], v23 offset:1024
    ds_read_b128 v[72:75], v23 offset:2048
    ds_read_b128 v[76:79], v23 offset:3072
    ds_read_b128 v[80:83], v23 offset:4096
    ds_read_b128 v[84:87], v23 offset:5120
    ds_read_b128 v[88:91], v23 offset:6144
    ds_read_b128 v[92:95], v23 offset:7168
    s_waitcnt vmcnt(10)
    s_barrier
    ds_read_b64_tr_b16 v[224:225], v33 offset:8192
    ds_read_b64_tr_b16 v[226:227], v33 offset:8704
    ds_read_b64_tr_b16 v[228:229], v33 offset:9216
    ds_read_b64_tr_b16 v[230:231], v33 offset:9728
    ds_read_b64_tr_b16 v[232:233], v33 offset:10240
    ds_read_b64_tr_b16 v[234:235], v33 offset:10752
    ds_read_b64_tr_b16 v[236:237], v33 offset:11264
    ds_read_b64_tr_b16 v[238:239], v33 offset:11776
    ds_read_b64_tr_b16 v[240:241], v33 offset:12288
    ds_read_b64_tr_b16 v[242:243], v33 offset:12800
    ds_read_b64_tr_b16 v[244:245], v33 offset:13312
    ds_read_b64_tr_b16 v[246:247], v33 offset:13824
    ds_read_b64_tr_b16 v[248:249], v33 offset:14336
    ds_read_b64_tr_b16 v[250:251], v33 offset:14848
    ds_read_b64_tr_b16 v[252:253], v33 offset:15360
    ds_read_b64_tr_b16 v[254:255], v33 offset:15872
    v_and_b32 v5, 31, v0
    v_lshlrev_b32 v20, 4, v5
    v_lshrrev_b32 v6, 5, v0
    v_lshl_add_u32 v16, v6, 11, v20
    v_add_u32 v17, 57344, v16
    v_add_u32 v20, 114688, v20
    s_lshl_b32 s29, s3, 9
    v_add_u32 v21, s29, v20
    s_lshl_b32 s29, s3, 7
    s_add_u32 s29, s29, 116736
    v_lshl_add_u32 v22, v5, 2, s29
    v_mul_u32_u24 v27, 7168, v6
    v_lshl_add_u32 v27, v5, 3, v27
    s_waitcnt vmcnt(8)
    v_mfma_f32_16x16x32_bf16 v[128:131], v[8:11], a[248:251], 0
    v_mfma_f32_16x16x32_bf16 v[132:135], v[10:13], a[248:251], 0
    v_mfma_f32_16x16x32_bf16 v[136:139], v[8:11], a[252:255], 0
    v_mfma_f32_16x16x32_bf16 v[140:143], v[10:13], a[252:255], 0
    s_add_u32 s37, s27, 12288
    s_waitcnt lgkmcnt(8)
    v_mfma_f32_16x16x32_bf16 v[128:131], v[224:227], v[144:147], v[128:131]
    v_mfma_f32_16x16x32_bf16 v[132:135], v[232:235], v[152:155], v[132:135]
    v_mfma_f32_16x16x32_bf16 v[128:131], v[228:231], v[148:151], v[128:131]
    buffer_load_dwordx4 a[0:3], v1, s[8:11], s37 offen offset:0
    v_mfma_f32_16x16x32_bf16 v[132:135], v[236:239], v[156:159], v[132:135]
    s_waitcnt lgkmcnt(0)
    v_mfma_f32_16x16x32_bf16 v[136:139], v[240:243], v[144:147], v[136:139]
    v_mfma_f32_16x16x32_bf16 v[140:143], v[248:251], v[152:155], v[140:143]
    buffer_load_dwordx4 a[4:7], v1, s[8:11], s37 offen offset:1024
    v_mfma_f32_16x16x32_bf16 v[136:139], v[244:247], v[148:151], v[136:139]
    s_nop 2
    v_add_f32 v176, v128, v132
    v_sub_f32 v180, v128, v132
    v_add_f32 v177, v129, v133
    v_sub_f32 v181, v129, v133
    s_add_u32 s37, s27, 26624
    v_mfma_f32_16x16x32_bf16 v[140:143], v[252:255], v[156:159], v[140:143]
    v_add_f32 v178, v130, v134
    v_sub_f32 v182, v130, v134
    v_add_f32 v179, v131, v135
    buffer_load_dwordx4 a[8:11], v1, s[8:11], s37 offen offset:0
    v_sub_f32 v183, v131, v135
    v_cvt_pk_bf16_f32 v160, v176, v177
    v_cvt_pk_bf16_f32 v164, v180, v181
    v_cvt_pk_bf16_f32 v161, v178, v179
    buffer_load_dwordx4 a[12:15], v1, s[8:11], s37 offen offset:1024
    v_cvt_pk_bf16_f32 v165, v182, v183
    v_add_f32 v184, v136, v140
    v_sub_f32 v188, v136, v140
    v_add_f32 v185, v137, v141
    v_sub_f32 v189, v137, v141
    s_add_u32 s37, s27, 40960
    v_add_f32 v186, v138, v142
    v_sub_f32 v190, v138, v142
    v_add_f32 v187, v139, v143
    v_sub_f32 v191, v139, v143
    buffer_load_dwordx4 a[16:19], v1, s[8:11], s37 offen offset:0
    v_cvt_pk_bf16_f32 v162, v184, v185
    v_cvt_pk_bf16_f32 v166, v188, v189
    v_cvt_pk_bf16_f32 v163, v186, v187
    v_cvt_pk_bf16_f32 v167, v190, v191
    buffer_load_dwordx4 a[20:23], v1, s[8:11], s37 offen offset:1024
    buffer_store_dwordx4 v[160:163], v25, s[8:11], s45 offen offset:0 sc1
    v_mfma_f32_16x16x32_bf16 v[240:243], v[160:163], v[160:163], 0
    v_mfma_f32_16x16x32_bf16 v[244:247], v[28:31], v[160:163], 0
    buffer_store_dwordx4 v[164:167], v25, s[8:11], s45 offen offset:1024 sc1
    v_mfma_f32_16x16x32_bf16 v[248:251], v[164:167], v[164:167], 0
    v_mfma_f32_16x16x32_bf16 v[252:255], v[28:31], v[164:167], 0
    ds_read_b128 v[96:99], v23 offset:8192
    ds_read_b128 v[100:103], v23 offset:9216
    ds_read_b128 v[104:107], v23 offset:10240
    ds_read_b128 v[108:111], v23 offset:11264
    ds_read_b128 v[112:115], v23 offset:12288
    ds_read_b128 v[116:119], v23 offset:13312
    ds_read_b128 v[120:123], v23 offset:14336
    ds_read_b128 v[124:127], v23 offset:15360
    v_cndmask_b32 v240, v240, v241, s[52:53]
    v_cndmask_b32 v242, v242, v243, s[52:53]
    v_cndmask_b32 v245, v240, v242, s[54:55]
    buffer_store_dwordx2 v[244:245], v26, s[8:11], s48 offen offset:0 sc1
    v_cndmask_b32 v248, v248, v249, s[52:53]
    v_cndmask_b32 v250, v250, v251, s[52:53]
    v_cndmask_b32 v253, v248, v250, s[54:55]
    buffer_store_dwordx2 v[252:253], v26, s[8:11], s48 offen offset:512 sc1
    s_waitcnt vmcnt(14)
    ds_read_b64_tr_b16 v[224:225], v4 offset:24576
    ds_read_b64_tr_b16 v[226:227], v4 offset:25088
    ds_read_b64_tr_b16 v[228:229], v4 offset:25600
    ds_read_b64_tr_b16 v[230:231], v4 offset:26112
    ds_read_b64_tr_b16 v[232:233], v4 offset:26624
    ds_read_b64_tr_b16 v[234:235], v4 offset:27136
    ds_read_b64_tr_b16 v[236:237], v4 offset:27648
    ds_read_b64_tr_b16 v[238:239], v4 offset:28160
    s_waitcnt vmcnt(10)
    s_waitcnt lgkmcnt(0)
    v_mfma_f32_16x16x32_bf16 v[128:131], v[8:11], a[200:203], 0
    s_lshl_b32 s29, s3, 7
    s_lshl2_add_u32 s29, s23, s29
    v_mfma_f32_16x16x32_bf16 v[132:135], v[10:13], a[200:203], 0
    v_mov_b32 v35, 1
    v_mov_b32 v36, 0x7fff0000
    v_mfma_f32_16x16x32_bf16 v[128:131], v[224:227], v[64:67], v[128:131]
    v_writelane_b32 v36, s29, 0
    v_min_u32 v32, 55, v0
    v_mfma_f32_16x16x32_bf16 v[132:135], v[232:235], v[72:75], v[132:135]
    v_mul_u32_u24 v34, 37, v32
    v_lshrrev_b32 v34, 9, v34
    v_mfma_f32_16x16x32_bf16 v[128:131], v[228:231], v[68:71], v[128:131]
    v_mul_u32_u24 v34, 72, v34
    s_add_u32 s37, s27, 55296
    v_mfma_f32_16x16x32_bf16 v[132:135], v[236:239], v[76:79], v[132:135]
    buffer_load_dwordx4 a[24:27], v1, s[8:11], s37 offen offset:0
    buffer_load_dwordx4 a[28:31], v1, s[8:11], s37 offen offset:1024
    s_add_u32 s37, s27, 0
    v_mfma_f32_16x16x32_bf16 v[136:139], v[8:11], a[204:207], 0
    v_lshl_add_u32 v32, v32, 2, v34
    v_min_u32 v34, 13, v0
    v_mfma_f32_16x16x32_bf16 v[140:143], v[10:13], a[204:207], 0
    s_lshl_b32 s29, s3, 7
    v_lshl_add_u32 v34, v34, 2, s29
    v_mfma_f32_16x16x32_bf16 v[136:139], v[224:227], v[80:83], v[136:139]
    s_lshl_b32 s35, s20, 9
    s_add_u32 s35, s35, 0x1e0000
    v_mfma_f32_16x16x32_bf16 v[140:143], v[232:235], v[88:91], v[140:143]
    s_add_u32 s56, s35, 8192
    s_add_u32 s57, s35, 16384
    v_mfma_f32_16x16x32_bf16 v[136:139], v[228:231], v[84:87], v[136:139]
    buffer_load_dwordx4 a[32:35], v1, s[8:11], s37 offen offset:0
    buffer_load_dwordx4 a[36:39], v1, s[8:11], s37 offen offset:1024
    v_mfma_f32_16x16x32_bf16 v[140:143], v[236:239], v[92:95], v[140:143]
    s_add_u32 s37, s27, 14336
    buffer_load_dwordx4 a[40:43], v1, s[8:11], s37 offen offset:0
    v_mfma_f32_16x16x32_bf16 v[144:147], v[8:11], a[208:211], 0
    v_add_f32 v176, v128, v132
    v_sub_f32 v180, v128, v132
    v_add_f32 v177, v129, v133
    v_mfma_f32_16x16x32_bf16 v[148:151], v[10:13], a[208:211], 0
    v_sub_f32 v181, v129, v133
    v_add_f32 v178, v130, v134
    v_sub_f32 v182, v130, v134
    v_mfma_f32_16x16x32_bf16 v[144:147], v[224:227], v[96:99], v[144:147]
    v_add_f32 v179, v131, v135
    v_sub_f32 v183, v131, v135
    v_cvt_pk_bf16_f32 v160, v176, v177
    v_mfma_f32_16x16x32_bf16 v[148:151], v[232:235], v[104:107], v[148:151]
    v_cvt_pk_bf16_f32 v164, v180, v181
    v_cvt_pk_bf16_f32 v161, v178, v179
    v_cvt_pk_bf16_f32 v165, v182, v183
    v_mfma_f32_16x16x32_bf16 v[144:147], v[228:231], v[100:103], v[144:147]
    ds_write_b64 v15, v[160:161] offset:24576
    ds_write_b64 v15, v[164:165] offset:25600
    buffer_load_dwordx4 a[44:47], v1, s[8:11], s37 offen offset:1024
    v_mfma_f32_16x16x32_bf16 v[148:151], v[236:239], v[108:111], v[148:151]
    s_add_u32 s37, s27, 28672
    buffer_load_dwordx4 a[48:51], v1, s[8:11], s37 offen offset:0
    buffer_load_dwordx4 a[52:55], v1, s[8:11], s37 offen offset:1024
    v_mfma_f32_16x16x32_bf16 v[152:155], v[8:11], a[212:215], 0
    v_add_f32 v184, v136, v140
    v_sub_f32 v188, v136, v140
    v_add_f32 v185, v137, v141
    v_mfma_f32_16x16x32_bf16 v[156:159], v[10:13], a[212:215], 0
    v_sub_f32 v189, v137, v141
    v_add_f32 v186, v138, v142
    v_sub_f32 v190, v138, v142
    v_mfma_f32_16x16x32_bf16 v[152:155], v[224:227], v[112:115], v[152:155]
    v_add_f32 v187, v139, v143
    v_sub_f32 v191, v139, v143
    v_cvt_pk_bf16_f32 v168, v184, v185
    v_mfma_f32_16x16x32_bf16 v[156:159], v[232:235], v[120:123], v[156:159]
    v_cvt_pk_bf16_f32 v172, v188, v189
    v_cvt_pk_bf16_f32 v169, v186, v187
    v_cvt_pk_bf16_f32 v173, v190, v191
    v_mfma_f32_16x16x32_bf16 v[152:155], v[228:231], v[116:119], v[152:155]
    ds_write_b64 v15, v[168:169] offset:24832
    ds_write_b64 v15, v[172:173] offset:25856
    s_add_u32 s37, s27, 43008
    v_mfma_f32_16x16x32_bf16 v[156:159], v[236:239], v[124:127], v[156:159]
    buffer_load_dwordx4 a[56:59], v1, s[8:11], s37 offen offset:0
    buffer_load_dwordx4 a[60:63], v1, s[8:11], s37 offen offset:1024
    s_waitcnt vmcnt(10)
    buffer_store_dword v35, v36, s[8:11], s35 offen sc1
    v_add_f32 v176, v144, v148
    v_sub_f32 v180, v144, v148
    v_add_f32 v177, v145, v149
    v_sub_f32 v181, v145, v149
    v_add_f32 v178, v146, v150
    v_sub_f32 v182, v146, v150
    v_add_f32 v179, v147, v151
    v_sub_f32 v183, v147, v151
    v_cvt_pk_bf16_f32 v160, v176, v177
    v_cvt_pk_bf16_f32 v164, v180, v181
    v_cvt_pk_bf16_f32 v161, v178, v179
    v_cvt_pk_bf16_f32 v165, v182, v183
    ds_write_b64 v15, v[160:161] offset:25088
    ds_write_b64 v15, v[164:165] offset:26112
    v_add_f32 v184, v152, v156
    v_sub_f32 v188, v152, v156
    v_add_f32 v185, v153, v157
    v_sub_f32 v189, v153, v157
    v_add_f32 v186, v154, v158
    v_sub_f32 v190, v154, v158
    v_add_f32 v187, v155, v159
    v_sub_f32 v191, v155, v159
    v_cvt_pk_bf16_f32 v168, v184, v185
    v_cvt_pk_bf16_f32 v172, v188, v189
    v_cvt_pk_bf16_f32 v169, v186, v187
    v_cvt_pk_bf16_f32 v173, v190, v191
    ds_write_b64 v15, v[168:169] offset:25344
    ds_write_b64 v15, v[172:173] offset:26368
    s_waitcnt lgkmcnt(0)
    s_barrier
    ds_read_b128 v[64:67], v16 offset:24576
    ds_read_b128 v[68:71], v16 offset:25600
    ds_read_b128 v[72:75], v16 offset:53248
    ds_read_b128 v[76:79], v16 offset:54272
    ds_read_b128 v[80:83], v17 offset:24576
    ds_read_b128 v[84:87], v17 offset:25600
    ds_read_b128 v[88:91], v17 offset:53248
    ds_read_b128 v[92:95], v17 offset:54272
    s_mul_i32 s38, s21, 112
    s_mul_i32 s31, s3, 2
    s_add_u32 s38, s38, s31
    s_lshl_b32 s38, s38, 11
    s_add_u32 s38, s38, 0xa00000
    s_and_b32 s32, s3, 1
    s_lshl_b32 s32, s32, 10
    s_lshr_b32 s31, s3, 1
    s_lshl_b32 s31, s31, 8
    s_or_b32 s32, s32, s31
    v_xor_b32 v2, s32, v1
    v_xor_b32 v3, 0x400, v2
    s_mul_i32 s29, s20, 448
    s_lshl_b32 s31, s28, 1
    s_add_u32 s29, s29, s31
    s_lshl_b32 s29, s29, 10
    s_add_u32 s58, s29, 0xc00000
    s_lshl_b32 s29, s20, 14
    s_lshl_b32 s30, s3, 8
    s_add_u32 s30, s30, s29
    s_add_u32 s30, s30, 0x1300000
    s_add_u32 s31, s30, 4096
    s_lshl_b32 s29, s20, 17
    s_lshl_b32 s49, s3, 13
    s_add_u32 s49, s49, s29
    s_add_u32 s49, s49, 0x1a00000
    s_waitcnt lgkmcnt(6)
    v_mfma_f32_32x32x16_bf16 v[128:143], a[0:3], v[64:67], 0
    ds_read_b128 v[96:99], v16 offset:25088
    s_add_u32 s37, s27, 2048
    buffer_load_dwordx4 a[64:67], v1, s[8:11], s37 offen offset:0
    v_mfma_f32_32x32x16_bf16 v[144:159], a[4:7], v[64:67], 0
    v_mfma_f32_32x32x16_bf16 v[160:175], a[0:3], v[68:71], 0
    ds_read_b128 v[100:103], v16 offset:26112
    buffer_load_dwordx4 a[68:71], v1, s[8:11], s37 offen offset:1024
    v_mfma_f32_32x32x16_bf16 v[176:191], a[4:7], v[68:71], 0
    s_waitcnt lgkmcnt(6)
    v_mfma_f32_32x32x16_bf16 v[128:143], a[8:11], v[72:75], v[128:143]
    ds_read_b128 v[104:107], v16 offset:53760
    s_add_u32 s37, s27, 16384
    buffer_load_dwordx4 a[72:75], v1, s[8:11], s37 offen offset:0
    v_mfma_f32_32x32x16_bf16 v[144:159], a[12:15], v[72:75], v[144:159]
    v_mfma_f32_32x32x16_bf16 v[160:175], a[8:11], v[76:79], v[160:175]
    ds_read_b128 v[108:111], v16 offset:54784
    buffer_load_dwordx4 a[76:79], v1, s[8:11], s37 offen offset:1024
    v_mfma_f32_32x32x16_bf16 v[176:191], a[12:15], v[76:79], v[176:191]
    s_waitcnt lgkmcnt(6)
    v_mfma_f32_32x32x16_bf16 v[128:143], a[16:19], v[80:83], v[128:143]
    ds_read_b128 v[64:67], v17 offset:25088
    v_mfma_f32_32x32x16_bf16 v[144:159], a[20:23], v[80:83], v[144:159]
    s_add_u32 s37, s27, 30720
    buffer_load_dwordx4 a[80:83], v1, s[8:11], s37 offen offset:0
    v_mfma_f32_32x32x16_bf16 v[160:175], a[16:19], v[84:87], v[160:175]
    ds_read_b128 v[68:71], v17 offset:26112
    v_mfma_f32_32x32x16_bf16 v[176:191], a[20:23], v[84:87], v[176:191]
    buffer_load_dwordx4 a[84:87], v1, s[8:11], s37 offen offset:1024
    s_waitcnt vmcnt(15)
    s_waitcnt lgkmcnt(6)
    v_mfma_f32_32x32x16_bf16 v[128:143], a[24:27], v[88:91], v[128:143]
    ds_read_b128 v[72:75], v17 offset:53760
    v_mfma_f32_32x32x16_bf16 v[144:159], a[28:31], v[88:91], v[144:159]
    s_add_u32 s37, s27, 45056
    buffer_load_dwordx4 a[88:91], v1, s[8:11], s37 offen offset:0
    v_mfma_f32_32x32x16_bf16 v[160:175], a[24:27], v[92:95], v[160:175]
    ds_read_b128 v[76:79], v17 offset:54784
    v_mfma_f32_32x32x16_bf16 v[176:191], a[28:31], v[92:95], v[176:191]
    s_waitcnt lgkmcnt(6)
    v_mfma_f32_32x32x16_bf16 v[192:207], a[0:3], v[96:99], 0
    buffer_load_dwordx4 a[92:95], v1, s[8:11], s37 offen offset:1024
    v_mfma_f32_32x32x16_bf16 v[208:223], a[4:7], v[96:99], 0
    v_mfma_f32_32x32x16_bf16 v[224:239], a[0:3], v[100:103], 0
    s_add_u32 s37, s27, 4096
    buffer_load_dwordx4 a[96:99], v1, s[8:11], s37 offen offset:0
    v_mfma_f32_32x32x16_bf16 v[240:255], a[4:7], v[100:103], 0
    s_waitcnt lgkmcnt(4)
    v_mfma_f32_32x32x16_bf16 v[192:207], a[8:11], v[104:107], v[192:207]
    buffer_load_dwordx4 a[100:103], v1, s[8:11], s37 offen offset:1024
    v_mfma_f32_32x32x16_bf16 v[208:223], a[12:15], v[104:107], v[208:223]
    v_mfma_f32_32x32x16_bf16 v[224:239], a[8:11], v[108:111], v[224:239]
    s_add_u32 s37, s27, 18432
    buffer_load_dwordx4 a[104:107], v1, s[8:11], s37 offen offset:0
    v_mfma_f32_32x32x16_bf16 v[240:255], a[12:15], v[108:111], v[240:255]
    s_waitcnt lgkmcnt(3)
    v_mfma_f32_32x32x16_bf16 v[192:207], a[16:19], v[64:67], v[192:207]
    v_mfma_f32_32x32x16_bf16 v[208:223], a[20:23], v[64:67], v[208:223]
    buffer_load_dwordx4 a[108:111], v1, s[8:11], s37 offen offset:1024
    s_waitcnt lgkmcnt(2)
    v_mfma_f32_32x32x16_bf16 v[224:239], a[16:19], v[68:71], v[224:239]
    buffer_load_dword v37, v32, s[8:11], s35 offen sc1
    v_mfma_f32_32x32x16_bf16 v[240:255], a[20:23], v[68:71], v[240:255]
    s_add_u32 s37, s27, 32768
    buffer_load_dwordx4 a[112:115], v1, s[8:11], s37 offen offset:0
    s_waitcnt lgkmcnt(1)
    v_mfma_f32_32x32x16_bf16 v[192:207], a[24:27], v[72:75], v[192:207]
    v_mfma_f32_32x32x16_bf16 v[208:223], a[28:31], v[72:75], v[208:223]
    buffer_load_dwordx4 a[116:119], v1, s[8:11], s37 offen offset:1024
    s_waitcnt lgkmcnt(0)
    v_mfma_f32_32x32x16_bf16 v[224:239], a[24:27], v[76:79], v[224:239]
    v_mfma_f32_32x32x16_bf16 v[240:255], a[28:31], v[76:79], v[240:255]
    s_waitcnt vmcnt(8)
    s_add_u32 s37, s27, 47104
    buffer_load_dwordx4 a[120:123], v1, s[8:11], s37 offen offset:0
    buffer_load_dwordx4 a[124:127], v1, s[8:11], s37 offen offset:1024
    s_waitcnt vmcnt(8)
    s_add_u32 s37, s27, 6144
    buffer_load_dwordx4 a[128:131], v1, s[8:11], s37 offen offset:0
    buffer_load_dwordx4 a[132:135], v1, s[8:11], s37 offen offset:1024
    s_waitcnt vmcnt(8)
    s_add_u32 s37, s27, 20480
    buffer_load_dwordx4 a[136:139], v1, s[8:11], s37 offen offset:0
    buffer_load_dwordx4 a[140:143], v1, s[8:11], s37 offen offset:1024
    s_waitcnt vmcnt(8)
    v_cmp_ne_u32 vcc, 1, v37
    s_nop 1
    s_cbranch_vccnz K2_P1_S
K2_P1_OK:
    s_add_u32 m0, s25, 0
    s_add_u32 s46, s49, 0
    buffer_load_dwordx4 v1, s[8:11], s46 offen offset:0 sc1 lds
    buffer_load_dwordx4 v1, s[8:11], s46 offen offset:1024 sc1 lds
    buffer_load_dwordx4 v1, s[8:11], s46 offen offset:2048 sc1 lds
    buffer_load_dwordx4 v1, s[8:11], s46 offen offset:3072 sc1 lds
    s_add_u32 m0, s25, 4096
    s_add_u32 s46, s49, 4096
    buffer_load_dwordx4 v1, s[8:11], s46 offen offset:0 sc1 lds
    buffer_load_dwordx4 v1, s[8:11], s46 offen offset:1024 sc1 lds
    buffer_load_dwordx4 v1, s[8:11], s46 offen offset:2048 sc1 lds
    buffer_load_dwordx4 v1, s[8:11], s46 offen offset:3072 sc1 lds
    s_add_u32 m0, s25, 8192
    s_add_u32 s46, s49, 32768
    buffer_load_dwordx4 v1, s[8:11], s46 offen offset:0 sc1 lds
    buffer_load_dwordx4 v1, s[8:11], s46 offen offset:1024 sc1 lds
    buffer_load_dwordx4 v1, s[8:11], s46 offen offset:2048 sc1 lds
    buffer_load_dwordx4 v1, s[8:11], s46 offen offset:3072 sc1 lds
    s_lshl_b32 s33, s22, 1
    s_lshl_b32 s34, s21, 4
    s_and_b32 s59, s3, 1
    s_lshl_b32 s59, s59, 3
    s_add_u32 s34, s34, s59
    s_and_b32 s59, s3, 2
    s_lshl_b32 s59, s59, 1
    s_add_u32 s34, s34, s59
    v_lshrrev_b32 v10, 5, v0
    v_and_b32 v11, 31, v0
    s_lshl_b32 s59, s33, 9
    v_lshl_add_u32 v12, v11, 4, s59
    s_lshl_b32 s59, s33, 7
    s_add_u32 s59, s59, 116736
    v_lshl_add_u32 v18, v11, 2, s59
    v_add_u32 v11, s34, v10
    v_mul_u32_u24 v13, 147, v11
    v_lshrrev_b32 v13, 10, v13
    v_mul_u32_u24 v14, 7, v13
    v_sub_u32 v14, v11, v14
    v_and_b32 v15, 3, v13
    v_lshrrev_b32 v13, 2, v13
    v_cmp_eq_u32 vcc, 6, v14
    v_lshl_add_u32 v8, v15, 1, v14
    v_and_b32 v14, 6, v14
    v_lshl_add_u32 v8, v14, 2, v8
    v_sub_u32 v8, v8, v14
    v_add_u32 v15, 24, v15
    v_cndmask_b32 v8, v8, v15, vcc
    v_mul_u32_u24 v13, 28672, v13
    v_lshrrev_b32 v14, 1, v8
    v_lshl_add_u32 v13, v14, 11, v13
    v_and_b32 v8, 1, v8
    v_lshl_add_u32 v13, v8, 3, v13
    v_add_u32 v38, v13, v12
    v_add_u32 v11, 2, v11
    v_mul_u32_u24 v13, 147, v11
    v_lshrrev_b32 v13, 10, v13
    v_mul_u32_u24 v14, 7, v13
    v_sub_u32 v14, v11, v14
    v_and_b32 v15, 3, v13
    v_lshrrev_b32 v13, 2, v13
    v_cmp_eq_u32 vcc, 6, v14
    v_lshl_add_u32 v8, v15, 1, v14
    v_and_b32 v14, 6, v14
    v_lshl_add_u32 v8, v14, 2, v8
    v_sub_u32 v8, v8, v14
    v_add_u32 v15, 24, v15
    v_cndmask_b32 v8, v8, v15, vcc
    v_mul_u32_u24 v13, 28672, v13
    v_lshrrev_b32 v14, 1, v8
    v_lshl_add_u32 v13, v14, 11, v13
    v_and_b32 v8, 1, v8
    v_lshl_add_u32 v13, v8, 3, v13
    v_add_u32 v39, v13, v12
    v_add_u32 v11, 2, v11
    v_lshlrev_b32 v4, 4, v10
    s_lshl_b32 s59, s34, 4
    s_add_u32 s59, s59, 8960
    buffer_load_dwordx4 v[40:43], v4, s[8:11], s59 offen offset:0
    buffer_load_dwordx4 v[44:47], v4, s[8:11], s59 offen offset:32
    v_and_b32 v19, 15, v0
    v_lshlrev_b32 v19, 1, v19
    v_bfe_u32 v14, v0, 4, 1
    v_add_u32 v19, v19, v14
    v_mul_u32_u24 v19, 14336, v19
    v_add_u32 v19, v19, v4
    s_mul_i32 s60, s33, 458752
    s_mul_i32 s59, s20, 896
    s_add_u32 s60, s60, s59
    s_lshl_b32 s59, s34, 3
    s_add_u32 s60, s60, s59
    s_add_u32 s61, s60, 458752
    s_lshl_b32 s62, s20, 2
    s_add_u32 s62, s62, s33
    s_mul_i32 s62, s62, 112
    s_mul_i32 s59, s3, 2
    s_add_u32 s62, s62, s59
    s_lshl_b32 s62, s62, 10
    s_add_u32 s62, s62, 0xc00000
    s_add_u32 s63, s62, 114688
    s_mov_b32 s12, s50
    s_mov_b32 s13, s51
    s_mov_b32 s14, 0x1c0000
    s_mov_b32 s15, 0x00020000
    s_xor_b32 s59, s3, 1
    s_mul_i32 s59, s59, 6144
    v_add_u32 v5, s59, v1
    s_xor_b32 s59, s3, 2
    s_mul_i32 s59, s59, 6144
    v_add_u32 v6, s59, v1
    s_xor_b32 s59, s3, 3
    s_mul_i32 s59, s59, 6144
    v_add_u32 v7, s59, v1
    s_mul_i32 s59, s3, 6144
    v_add_u32 v14, s59, v1
    s_waitcnt vmcnt(10)
    s_barrier
    ds_read_b128 v[80:83], v16 offset:0
    ds_read_b128 v[84:87], v16 offset:1024
    ds_read_b128 v[88:91], v16 offset:512
    s_waitcnt lgkmcnt(2)
    v_mfma_f32_32x32x16_bf16 v[128:143], a[32:35], v[80:83], v[128:143]
    ds_read_b128 v[92:95], v16 offset:1536
    s_add_u32 m0, s25, 12288
    s_add_u32 s46, s49, 36864
    v_mfma_f32_32x32x16_bf16 v[144:159], a[36:39], v[80:83], v[144:159]
    ds_read_b128 v[96:99], v16 offset:28672
    buffer_load_dwordx4 v1, s[8:11], s46 offen offset:0 sc1 lds
    s_waitcnt lgkmcnt(3)
    v_mfma_f32_32x32x16_bf16 v[160:175], a[32:35], v[84:87], v[160:175]
    ds_read_b128 v[100:103], v16 offset:29696
    buffer_load_dwordx4 v1, s[8:11], s46 offen offset:1024 sc1 lds
    v_mfma_f32_32x32x16_bf16 v[176:191], a[36:39], v[84:87], v[176:191]
    ds_read_b128 v[104:107], v16 offset:29184
    s_waitcnt lgkmcnt(4)
    v_mfma_f32_32x32x16_bf16 v[192:207], a[32:35], v[88:91], v[192:207]
    ds_read_b128 v[108:111], v16 offset:30208
    buffer_load_dwordx4 v1, s[8:11], s46 offen offset:2048 sc1 lds
    v_mfma_f32_32x32x16_bf16 v[208:223], a[36:39], v[88:91], v[208:223]
    ds_read_b128 v[64:67], v17 offset:0
    s_waitcnt lgkmcnt(5)
    v_mfma_f32_32x32x16_bf16 v[224:239], a[32:35], v[92:95], v[224:239]
    ds_read_b128 v[68:71], v17 offset:1024
    buffer_load_dwordx4 v1, s[8:11], s46 offen offset:3072 sc1 lds
    v_mfma_f32_32x32x16_bf16 v[240:255], a[36:39], v[92:95], v[240:255]
    ds_read_b128 v[72:75], v17 offset:512
    buffer_load_dwordx2 v[112:113], v27, s[8:11], s30 offen offset:0 sc1
    s_waitcnt lgkmcnt(5)
    v_mfma_f32_32x32x16_bf16 v[128:143], a[40:43], v[96:99], v[128:143]
    ds_read_b128 v[76:79], v17 offset:1536
    s_lshl_b32 s64, s23, 13
    s_sub_u32 s78, 0, s22
    v_mfma_f32_32x32x16_bf16 v[144:159], a[44:47], v[96:99], v[144:159]
    ds_read_b128 v[80:83], v17 offset:28672
    s_mov_b32 s79, s78
    buffer_load_dwordx2 v[114:115], v27, s[8:11], s30 offen offset:1024 sc1
    v_mfma_f32_32x32x16_bf16 v[160:175], a[40:43], v[100:103], v[160:175]
    ds_read_b128 v[84:87], v17 offset:29696
    s_cmp_le_u32 s23, 0
    s_addc_u32 s65, 0, 0
    v_mfma_f32_32x32x16_bf16 v[176:191], a[44:47], v[100:103], v[176:191]
    s_lshl_b32 s65, s65, 13
    buffer_load_dwordx2 v[116:117], v27, s[8:11], s30 offen offset:2048 sc1
    s_waitcnt lgkmcnt(6)
    v_mfma_f32_32x32x16_bf16 v[192:207], a[40:43], v[104:107], v[192:207]
    ds_read_b128 v[88:91], v17 offset:29184
    s_cmp_le_u32 s23, 1
    s_addc_u32 s66, 1, 0
    v_mfma_f32_32x32x16_bf16 v[208:223], a[44:47], v[104:107], v[208:223]
    s_lshl_b32 s66, s66, 13
    buffer_load_dwordx2 v[118:119], v27, s[8:11], s30 offen offset:3072 sc1
    v_mfma_f32_32x32x16_bf16 v[224:239], a[40:43], v[108:111], v[224:239]
    ds_read_b128 v[92:95], v17 offset:30208
    s_cmp_le_u32 s23, 2
    s_addc_u32 s67, 2, 0
    v_mfma_f32_32x32x16_bf16 v[240:255], a[44:47], v[108:111], v[240:255]
    s_lshl_b32 s67, s67, 13
    buffer_load_dwordx2 v[120:121], v27, s[8:11], s31 offen offset:0 sc1
    s_waitcnt lgkmcnt(6)
    v_mfma_f32_32x32x16_bf16 v[128:143], a[48:51], v[64:67], v[128:143]
    s_cmp_le_u32 s23, 3
    s_addc_u32 s68, 3, 0
    s_lshl_b32 s68, s68, 13
    v_mfma_f32_32x32x16_bf16 v[144:159], a[52:55], v[64:67], v[144:159]
    s_cmp_le_u32 s23, 4
    s_addc_u32 s69, 4, 0
    buffer_load_dwordx2 v[122:123], v27, s[8:11], s31 offen offset:1024 sc1
    v_mfma_f32_32x32x16_bf16 v[160:175], a[48:51], v[68:71], v[160:175]
    s_lshl_b32 s69, s69, 13
    buffer_load_dwordx2 v[124:125], v27, s[8:11], s31 offen offset:2048 sc1
    v_mfma_f32_32x32x16_bf16 v[176:191], a[52:55], v[68:71], v[176:191]
    s_cmp_le_u32 s23, 5
    s_addc_u32 s70, 5, 0
    s_add_u32 m0, s25, 16384
    s_add_u32 s46, s49, 65536
    s_waitcnt lgkmcnt(4)
    v_mfma_f32_32x32x16_bf16 v[192:207], a[48:51], v[72:75], v[192:207]
    s_lshl_b32 s70, s70, 13
    buffer_load_dwordx4 v1, s[8:11], s46 offen offset:0 sc1 lds
    v_mfma_f32_32x32x16_bf16 v[208:223], a[52:55], v[72:75], v[208:223]
    s_cmp_le_u32 s23, 6
    s_addc_u32 s71, 6, 0
    buffer_load_dwordx4 v1, s[8:11], s46 offen offset:1024 sc1 lds
    v_mfma_f32_32x32x16_bf16 v[224:239], a[48:51], v[76:79], v[224:239]
    s_lshl_b32 s71, s71, 13
    v_mfma_f32_32x32x16_bf16 v[240:255], a[52:55], v[76:79], v[240:255]
    s_cmp_le_u32 s23, 7
    s_addc_u32 s72, 7, 0
    s_waitcnt lgkmcnt(3)
    v_mfma_f32_32x32x16_bf16 v[128:143], a[56:59], v[80:83], v[128:143]
    s_lshl_b32 s72, s72, 13
    buffer_load_dwordx4 v1, s[8:11], s46 offen offset:2048 sc1 lds
    v_mfma_f32_32x32x16_bf16 v[144:159], a[60:63], v[80:83], v[144:159]
    s_cmp_le_u32 s23, 8
    s_addc_u32 s73, 8, 0
    s_lshl_b32 s73, s73, 13
    s_waitcnt vmcnt(20)
    s_barrier
    s_waitcnt lgkmcnt(2)
    v_mfma_f32_32x32x16_bf16 v[160:175], a[56:59], v[84:87], v[160:175]
    ds_read_b128 v[96:99], v16 offset:4096
    s_cmp_le_u32 s23, 9
    s_addc_u32 s74, 9, 0
    v_mfma_f32_32x32x16_bf16 v[176:191], a[60:63], v[84:87], v[176:191]
    ds_read_b128 v[100:103], v16 offset:5120
    s_lshl_b32 s74, s74, 13
    buffer_load_dwordx4 v1, s[8:11], s46 offen offset:3072 sc1 lds
    s_waitcnt lgkmcnt(3)
    v_mfma_f32_32x32x16_bf16 v[192:207], a[56:59], v[88:91], v[192:207]
    ds_read_b128 v[104:107], v16 offset:32768
    s_cmp_le_u32 s23, 10
    s_addc_u32 s75, 10, 0
    s_add_u32 m0, s25, 20480
    s_add_u32 s46, s49, 69632
    v_mfma_f32_32x32x16_bf16 v[208:223], a[60:63], v[88:91], v[208:223]
    ds_read_b128 v[108:111], v16 offset:33792
    s_lshl_b32 s75, s75, 13
    buffer_load_dwordx4 v1, s[8:11], s46 offen offset:0 sc1 lds
    s_waitcnt lgkmcnt(4)
    v_mfma_f32_32x32x16_bf16 v[224:239], a[56:59], v[92:95], v[224:239]
    ds_read_b128 v[64:67], v17 offset:4096
    s_cmp_le_u32 s23, 11
    s_addc_u32 s76, 11, 0
    v_mfma_f32_32x32x16_bf16 v[240:255], a[60:63], v[92:95], v[240:255]
    ds_read_b128 v[68:71], v17 offset:5120
    s_lshl_b32 s76, s76, 13
    buffer_load_dwordx4 v1, s[8:11], s46 offen offset:1024 sc1 lds
    s_waitcnt lgkmcnt(4)
    v_mfma_f32_32x32x16_bf16 v[128:143], a[64:67], v[96:99], v[128:143]
    ds_read_b128 v[72:75], v17 offset:32768
    s_cmp_le_u32 s23, 12
    s_addc_u32 s77, 12, 0
    v_mfma_f32_32x32x16_bf16 v[144:159], a[68:71], v[96:99], v[144:159]
    ds_read_b128 v[76:79], v17 offset:33792
    s_lshl_b32 s77, s77, 13
    buffer_load_dwordx4 v1, s[8:11], s46 offen offset:2048 sc1 lds
    v_mfma_f32_32x32x16_bf16 v[160:175], a[64:67], v[100:103], v[160:175]
    buffer_load_dwordx4 v1, s[8:11], s46 offen offset:3072 sc1 lds
    v_mfma_f32_32x32x16_bf16 v[176:191], a[68:71], v[100:103], v[176:191]
    s_add_u32 s37, s27, 34816
    s_waitcnt lgkmcnt(4)
    v_mfma_f32_32x32x16_bf16 v[128:143], a[72:75], v[104:107], v[128:143]
    buffer_load_dwordx4 a[144:147], v1, s[8:11], s37 offen offset:0
    v_mfma_f32_32x32x16_bf16 v[144:159], a[76:79], v[104:107], v[144:159]
    v_mfma_f32_32x32x16_bf16 v[160:175], a[72:75], v[108:111], v[160:175]
    buffer_load_dwordx4 a[148:151], v1, s[8:11], s37 offen offset:1024
    v_mfma_f32_32x32x16_bf16 v[176:191], a[76:79], v[108:111], v[176:191]
    s_add_u32 s37, s27, 49152
    s_waitcnt lgkmcnt(3)
    v_mfma_f32_32x32x16_bf16 v[128:143], a[80:83], v[64:67], v[128:143]
    buffer_load_dwordx4 a[152:155], v1, s[8:11], s37 offen offset:0
    v_mfma_f32_32x32x16_bf16 v[144:159], a[84:87], v[64:67], v[144:159]
    s_waitcnt vmcnt(18)
    s_barrier
    s_waitcnt lgkmcnt(2)
    v_mfma_f32_32x32x16_bf16 v[160:175], a[80:83], v[68:71], v[160:175]
    ds_read_b128 v[80:83], v16 offset:8192
    buffer_load_dwordx4 a[156:159], v1, s[8:11], s37 offen offset:1024
    v_mfma_f32_32x32x16_bf16 v[176:191], a[84:87], v[68:71], v[176:191]
    ds_read_b128 v[84:87], v16 offset:9216
    s_add_u32 s37, s27, 8192
    s_waitcnt lgkmcnt(3)
    v_mfma_f32_32x32x16_bf16 v[128:143], a[88:91], v[72:75], v[128:143]
    ds_read_b128 v[88:91], v16 offset:36864
    buffer_load_dwordx4 a[160:163], v1, s[8:11], s37 offen offset:0
    s_waitcnt vmcnt(13)
    v_mfma_f32_32x32x16_bf16 v[144:159], a[92:95], v[72:75], v[144:159]
    ds_read_b128 v[92:95], v16 offset:37888
    v_add_f32 v112, v112, v114
    v_add_f32 v113, v113, v115
    v_add_f32 v116, v116, v118
    v_add_f32 v117, v117, v119
    v_add_f32 v120, v120, v122
    v_add_f32 v121, v121, v123
    s_waitcnt lgkmcnt(4)
    v_mfma_f32_32x32x16_bf16 v[160:175], a[88:91], v[76:79], v[160:175]
    ds_read_b128 v[96:99], v17 offset:8192
    buffer_load_dwordx4 a[164:167], v1, s[8:11], s37 offen offset:1024
    v_add_f32 v112, v112, v116
    v_mfma_f32_32x32x16_bf16 v[176:191], a[92:95], v[76:79], v[176:191]
    ds_read_b128 v[100:103], v17 offset:9216
    s_add_u32 s37, s27, 22528
    v_add_f32 v113, v113, v117
    v_add_f32 v120, v120, v124
    v_add_f32 v121, v121, v125
    v_add_f32 v112, v112, v120
    s_waitcnt lgkmcnt(4)
    v_mfma_f32_32x32x16_bf16 v[128:143], a[96:99], v[80:83], v[128:143]
    ds_read_b128 v[104:107], v17 offset:36864
    buffer_load_dwordx4 a[168:171], v1, s[8:11], s37 offen offset:0
    v_add_f32 v113, v113, v121
    v_mfma_f32_32x32x16_bf16 v[144:159], a[100:103], v[80:83], v[144:159]
    ds_read_b128 v[108:111], v17 offset:37888
    v_mov_b32 v114, v112
    v_mov_b32 v115, v113
    v_mov_b32 v31, 0
    v_permlane32_swap_b32 v112, v114
    v_permlane32_swap_b32 v113, v115
    v_add_f32 v112, v112, v114
    v_mfma_f32_32x32x16_bf16 v[160:175], a[96:99], v[84:87], v[160:175]
    ds_read_b128 v[64:67], v16 offset:12288
    buffer_load_dwordx4 a[172:175], v1, s[8:11], s37 offen offset:1024
    v_add_f32 v114, v113, v115
    v_mfma_f32_32x32x16_bf16 v[176:191], a[100:103], v[84:87], v[176:191]
    ds_read_b128 v[68:71], v16 offset:13312
    s_add_u32 s37, s27, 36864
    v_mul_f32 v112, 0x3b124925, v112
    v_mul_f32 v114, 0x3b124925, v114
    v_fma_f32 v114, -v112, v112, v114
    v_max_f32 v114, 0, v114
    s_waitcnt lgkmcnt(6)
    v_mfma_f32_32x32x16_bf16 v[128:143], a[104:107], v[88:91], v[128:143]
    ds_read_b128 v[72:75], v16 offset:40960
    buffer_load_dwordx4 a[176:179], v1, s[8:11], s37 offen offset:0
    v_cvt_pk_bf16_f32 v28, -v112, -v112
    v_mfma_f32_32x32x16_bf16 v[144:159], a[108:111], v[88:91], v[144:159]
    v_cvt_pk_bf16_f32 v114, v114, v114
    v_lshlrev_b32 v114, 16, v114
    v_add_f32 v114, 0x3727c5ac, v114
    v_cvt_pk_bf16_f32 v114, v114, v114
    v_lshlrev_b32 v114, 16, v114
    v_mfma_f32_32x32x16_bf16 v[160:175], a[104:107], v[92:95], v[160:175]
    ds_read_b128 v[76:79], v16 offset:41984
    buffer_load_dwordx4 a[180:183], v1, s[8:11], s37 offen offset:1024
    v_mfma_f32_32x32x16_bf16 v[176:191], a[108:111], v[92:95], v[176:191]
    s_add_u32 s37, s27, 51200
    v_sqrt_f32 v114, v114
    s_nop 0
    v_cvt_pk_bf16_f32 v30, v114, v114
    s_waitcnt lgkmcnt(6)
    v_mfma_f32_32x32x16_bf16 v[128:143], a[112:115], v[96:99], v[128:143]
    ds_read_b128 v[80:83], v17 offset:12288
    buffer_load_dwordx4 a[184:187], v1, s[8:11], s37 offen offset:0
    v_cvt_pk_bf16_f32 v29, -v112, v114
    v_mfma_f32_32x32x16_bf16 v[144:159], a[116:119], v[96:99], v[144:159]
    v_lshlrev_b32 v114, 16, v30
    v_rcp_f32 v114, v114
    ds_write_b128 v21, v[28:31]
    v_mul_f32 v114, v114, v114
    ds_write_b32 v22, v114
    v_mfma_f32_32x32x16_bf16 v[160:175], a[112:115], v[100:103], v[160:175]
    ds_read_b128 v[84:87], v17 offset:13312
    buffer_load_dwordx4 a[188:191], v1, s[8:11], s37 offen offset:1024
    v_mfma_f32_32x32x16_bf16 v[176:191], a[116:119], v[100:103], v[176:191]
    s_add_u32 s37, s27, 10240
    s_waitcnt lgkmcnt(8)
    v_mfma_f32_32x32x16_bf16 v[128:143], a[120:123], v[104:107], v[128:143]
    ds_read_b128 v[88:91], v17 offset:40960
    buffer_load_dwordx4 a[192:195], v1, s[8:11], s37 offen offset:0
    v_mfma_f32_32x32x16_bf16 v[144:159], a[124:127], v[104:107], v[144:159]
    v_mfma_f32_32x32x16_bf16 v[160:175], a[120:123], v[108:111], v[160:175]
    ds_read_b128 v[92:95], v17 offset:41984
    buffer_load_dwordx4 a[196:199], v1, s[8:11], s37 offen offset:1024
    v_mfma_f32_32x32x16_bf16 v[176:191], a[124:127], v[108:111], v[176:191]
    s_add_u32 s37, s27, 24576
    s_waitcnt lgkmcnt(8)
    v_mfma_f32_32x32x16_bf16 v[128:143], a[128:131], v[64:67], v[128:143]
    buffer_load_dwordx4 a[200:203], v1, s[8:11], s37 offen offset:0
    v_mfma_f32_32x32x16_bf16 v[144:159], a[132:135], v[64:67], v[144:159]
    v_mfma_f32_32x32x16_bf16 v[160:175], a[128:131], v[68:71], v[160:175]
    buffer_load_dwordx4 a[204:207], v1, s[8:11], s37 offen offset:1024
    v_mfma_f32_32x32x16_bf16 v[176:191], a[132:135], v[68:71], v[176:191]
    s_add_u32 s37, s27, 38912
    s_waitcnt lgkmcnt(6)
    v_mfma_f32_32x32x16_bf16 v[128:143], a[136:139], v[72:75], v[128:143]
    buffer_load_dwordx4 a[208:211], v1, s[8:11], s37 offen offset:0
    v_mfma_f32_32x32x16_bf16 v[144:159], a[140:143], v[72:75], v[144:159]
    v_mfma_f32_32x32x16_bf16 v[160:175], a[136:139], v[76:79], v[160:175]
    buffer_load_dwordx4 a[212:215], v1, s[8:11], s37 offen offset:1024
    v_mfma_f32_32x32x16_bf16 v[176:191], a[140:143], v[76:79], v[176:191]
    s_add_u32 s37, s27, 53248
    s_waitcnt vmcnt(16)
    s_waitcnt lgkmcnt(5)
    v_mfma_f32_32x32x16_bf16 v[128:143], a[144:147], v[80:83], v[128:143]
    buffer_load_dwordx4 a[216:219], v1, s[8:11], s37 offen offset:0
    v_mfma_f32_32x32x16_bf16 v[144:159], a[148:151], v[80:83], v[144:159]
    s_waitcnt lgkmcnt(3)
    s_barrier
    s_waitcnt lgkmcnt(2)
    v_mfma_f32_32x32x16_bf16 v[160:175], a[144:147], v[84:87], v[160:175]
    ds_read_b128 v[96:99], v16 offset:16384
    buffer_load_dwordx4 a[220:223], v1, s[8:11], s37 offen offset:1024
    ds_read_b64 v[56:57], v38
    v_mfma_f32_32x32x16_bf16 v[176:191], a[148:151], v[84:87], v[176:191]
    ds_read_b128 v[100:103], v16 offset:17408
    s_add_u32 s37, s27, 57344
    ds_read_b64 v[8:9], v38 offset:512
    ds_read_b64 v[58:59], v39
    ds_read_b64 v[10:11], v39 offset:512
    ds_read_b32 v12, v18
    s_waitcnt vmcnt(16)
    s_waitcnt lgkmcnt(8)
    v_mfma_f32_32x32x16_bf16 v[128:143], a[152:155], v[88:91], v[128:143]
    ds_read_b128 v[104:107], v16 offset:45056
    buffer_load_dwordx4 a[224:227], v1, s[8:11], s37 offen offset:0
    ds_read_b32 v13, v18 offset:128
    v_mfma_f32_32x32x16_bf16 v[144:159], a[156:159], v[88:91], v[144:159]
    ds_read_b128 v[108:111], v17 offset:16384
    s_waitcnt lgkmcnt(10)
    v_mfma_f32_32x32x16_bf16 v[160:175], a[152:155], v[92:95], v[160:175]
    ds_read_b128 v[64:67], v17 offset:45056
    buffer_load_dwordx4 a[228:231], v1, s[8:11], s37 offen offset:1024
    v_mfma_f32_32x32x16_bf16 v[176:191], a[156:159], v[92:95], v[176:191]
    ds_read_b128 v[68:71], v16 offset:20480
    s_lshl1_add_u32 s39, s64, s38
    s_waitcnt vmcnt(16)
    s_waitcnt lgkmcnt(9)
    v_mfma_f32_32x32x16_bf16 v[128:143], a[160:163], v[96:99], v[128:143]
    ds_read_b128 v[72:75], v16 offset:49152
    buffer_load_dwordx4 a[232:235], v2, s[8:11], s39 offen offset:0
    v_mfma_f32_32x32x16_bf16 v[144:159], a[164:167], v[96:99], v[144:159]
    ds_read_b128 v[76:79], v17 offset:20480
    v_mfma_f32_32x32x16_bf16 v[160:175], a[160:163], v[100:103], v[160:175]
    ds_read_b128 v[80:83], v17 offset:49152
    buffer_load_dwordx4 a[236:239], v3, s[8:11], s39 offen offset:0
    v_mfma_f32_32x32x16_bf16 v[176:191], a[164:167], v[100:103], v[176:191]
    ds_read_b128 v[84:87], v20 offset:0
    s_waitcnt vmcnt(16)
    s_waitcnt lgkmcnt(6)
    v_mfma_f32_32x32x16_bf16 v[128:143], a[168:171], v[104:107], v[128:143]
    ds_read_b128 v[88:91], v16 offset:46080
    buffer_load_dwordx4 a[240:243], v2, s[8:11], s39 offen offset:2048
    v_mfma_f32_32x32x16_bf16 v[144:159], a[172:175], v[104:107], v[144:159]
    s_waitcnt vmcnt(15)
    v_mfma_f32_32x32x16_bf16 v[128:143], a[176:179], v[108:111], v[128:143]
    ds_read_b128 v[92:95], v17 offset:17408
    buffer_load_dwordx4 a[244:247], v3, s[8:11], s39 offen offset:2048
    v_mfma_f32_32x32x16_bf16 v[144:159], a[180:183], v[108:111], v[144:159]
    s_lshl1_add_u32 s39, s65, s38
    v_mul_f32 v48, v13, v40
    v_mul_f32 v49, v13, v41
    v_mul_f32 v50, v13, v42
    s_waitcnt vmcnt(14)
    s_waitcnt lgkmcnt(6)
    v_mfma_f32_32x32x16_bf16 v[128:143], a[184:187], v[64:67], v[128:143]
    ds_read_b128 v[96:99], v17 offset:46080
    buffer_load_dwordx4 a[248:251], v2, s[8:11], s39 offen offset:0
    v_mul_f32 v51, v13, v43
    v_mfma_f32_32x32x16_bf16 v[144:159], a[188:191], v[64:67], v[144:159]
    v_mul_f32 v52, v13, v44
    v_mul_f32 v53, v13, v45
    v_mul_f32 v54, v13, v46
    v_mul_f32 v55, v13, v47
    v_mul_f32 v40, v12, v40
    v_mul_f32 v41, v12, v41
    s_waitcnt vmcnt(13)
    v_mfma_f32_32x32x16_bf16 v[128:143], a[192:195], v[68:71], v[128:143]
    ds_read_b128 v[100:103], v16 offset:21504
    buffer_load_dwordx4 a[252:255], v3, s[8:11], s39 offen offset:0
    v_mul_f32 v42, v12, v42
    v_mfma_f32_32x32x16_bf16 v[144:159], a[196:199], v[68:71], v[144:159]
    v_mul_f32 v43, v12, v43
    v_mul_f32 v44, v12, v44
    v_mul_f32 v45, v12, v45
    v_mul_f32 v46, v12, v46
    v_mul_f32 v47, v12, v47
    s_waitcnt vmcnt(12)
    s_waitcnt lgkmcnt(6)
    v_mfma_f32_32x32x16_bf16 v[128:143], a[200:203], v[72:75], v[128:143]
    ds_read_b128 v[104:107], v16 offset:50176
    buffer_load_dwordx4 a[0:3], v2, s[8:11], s39 offen offset:2048
    v_mfma_f32_32x32x16_bf16 v[144:159], a[204:207], v[72:75], v[144:159]
    s_waitcnt vmcnt(11)
    v_mfma_f32_32x32x16_bf16 v[128:143], a[208:211], v[76:79], v[128:143]
    ds_read_b128 v[108:111], v17 offset:21504
    buffer_load_dwordx4 a[4:7], v3, s[8:11], s39 offen offset:2048
    v_mfma_f32_32x32x16_bf16 v[144:159], a[212:215], v[76:79], v[144:159]
    s_lshl1_add_u32 s39, s66, s38
    s_waitcnt vmcnt(10)
    s_waitcnt lgkmcnt(6)
    v_mfma_f32_32x32x16_bf16 v[128:143], a[216:219], v[80:83], v[128:143]
    ds_read_b128 v[64:67], v17 offset:50176
    buffer_load_dwordx4 a[8:11], v2, s[8:11], s39 offen offset:0
    v_mfma_f32_32x32x16_bf16 v[144:159], a[220:223], v[80:83], v[144:159]
    s_waitcnt vmcnt(9)
    v_mfma_f32_32x32x16_bf16 v[128:143], a[224:227], v[84:87], v[128:143]
    ds_read_b128 v[68:71], v20 offset:1024
    buffer_load_dwordx4 a[12:15], v3, s[8:11], s39 offen offset:0
    v_mfma_f32_32x32x16_bf16 v[144:159], a[228:231], v[84:87], v[144:159]
    s_waitcnt lgkmcnt(6)
    v_mfma_f32_32x32x16_bf16 v[160:175], a[168:171], v[88:91], v[160:175]
    ds_read_b128 v[72:75], v20 offset:512
    buffer_load_dwordx4 a[16:19], v2, s[8:11], s39 offen offset:2048
    v_mfma_f32_32x32x16_bf16 v[176:191], a[172:175], v[88:91], v[176:191]
    s_add_u32 s29, s58, 0
    s_nop 2
    v_max_f32 v128, 0, v128
    v_max_f32 v129, 0, v129
    v_max_f32 v130, 0, v130
    v_max_f32 v131, 0, v131
    v_max_f32 v132, 0, v132
    v_mfma_f32_32x32x16_bf16 v[160:175], a[176:179], v[92:95], v[160:175]
    ds_read_b128 v[76:79], v20 offset:1536
    buffer_load_dwordx4 a[20:23], v3, s[8:11], s39 offen offset:2048
    v_max_f32 v133, 0, v133
    v_mfma_f32_32x32x16_bf16 v[176:191], a[180:183], v[92:95], v[176:191]
    s_lshl1_add_u32 s39, s67, s38
    v_max_f32 v134, 0, v134
    v_max_f32 v135, 0, v135
    v_mul_f32 v128, v128, v144
    v_mul_f32 v129, v129, v145
    s_waitcnt lgkmcnt(6)
    v_mfma_f32_32x32x16_bf16 v[160:175], a[184:187], v[96:99], v[160:175]
    ds_read_b128 v[80:83], v16 offset:4608
    buffer_load_dwordx4 a[24:27], v2, s[8:11], s39 offen offset:0
    v_mul_f32 v130, v130, v146
    v_mfma_f32_32x32x16_bf16 v[176:191], a[188:191], v[96:99], v[176:191]
    v_mul_f32 v131, v131, v147
    v_mul_f32 v132, v132, v148
    v_mul_f32 v133, v133, v149
    v_mul_f32 v134, v134, v150
    v_mul_f32 v135, v135, v151
    v_cvt_pk_bf16_f32 v144, v128, v129
    v_mfma_f32_32x32x16_bf16 v[160:175], a[192:195], v[100:103], v[160:175]
    ds_read_b128 v[84:87], v16 offset:5632
    buffer_load_dwordx4 a[28:31], v3, s[8:11], s39 offen offset:0
    v_cvt_pk_bf16_f32 v145, v130, v131
    v_mfma_f32_32x32x16_bf16 v[176:191], a[196:199], v[100:103], v[176:191]
    v_cvt_pk_bf16_f32 v146, v132, v133
    v_cvt_pk_bf16_f32 v147, v134, v135
    s_waitcnt lgkmcnt(6)
    v_mfma_f32_32x32x16_bf16 v[160:175], a[200:203], v[104:107], v[160:175]
    ds_read_b128 v[88:91], v16 offset:33280
    buffer_store_dwordx4 v[144:147], v1, s[8:11], s29 offen offset:0 sc1
    v_mfma_f32_32x32x16_bf16 v[176:191], a[204:207], v[104:107], v[176:191]
    v_max_f32 v136, 0, v136
    v_max_f32 v137, 0, v137
    v_max_f32 v138, 0, v138
    v_max_f32 v139, 0, v139
    v_max_f32 v140, 0, v140
    v_max_f32 v141, 0, v141
    v_mfma_f32_32x32x16_bf16 v[160:175], a[208:211], v[108:111], v[160:175]
    ds_read_b128 v[92:95], v16 offset:34304
    v_max_f32 v142, 0, v142
    v_max_f32 v143, 0, v143
    v_mul_f32 v136, v136, v152
    v_mul_f32 v137, v137, v153
    v_mul_f32 v138, v138, v154
    v_mfma_f32_32x32x16_bf16 v[176:191], a[212:215], v[108:111], v[176:191]
    v_mul_f32 v139, v139, v155
    v_mul_f32 v140, v140, v156
    v_mul_f32 v141, v141, v157
    v_mul_f32 v142, v142, v158
    v_mul_f32 v143, v143, v159
    s_waitcnt lgkmcnt(6)
    v_mfma_f32_32x32x16_bf16 v[160:175], a[216:219], v[64:67], v[160:175]
    ds_read_b128 v[96:99], v17 offset:4608
    buffer_load_dwordx4 a[32:35], v2, s[8:11], s39 offen offset:2048
    v_cvt_pk_bf16_f32 v148, v136, v137
    v_mfma_f32_32x32x16_bf16 v[176:191], a[220:223], v[64:67], v[176:191]
    v_cvt_pk_bf16_f32 v149, v138, v139
    v_cvt_pk_bf16_f32 v150, v140, v141
    v_cvt_pk_bf16_f32 v151, v142, v143
    v_mfma_f32_32x32x16_bf16 v[160:175], a[224:227], v[68:71], v[160:175]
    ds_read_b128 v[100:103], v17 offset:5632
    buffer_store_dwordx4 v[148:151], v1, s[8:11], s29 offen offset:1024 sc1
    v_mfma_f32_32x32x16_bf16 v[176:191], a[228:231], v[68:71], v[176:191]
    s_waitcnt lgkmcnt(6)
    v_mfma_f32_32x32x16_bf16 v[192:207], a[224:227], v[72:75], v[192:207]
    ds_read_b128 v[104:107], v17 offset:33280
    v_mfma_f32_32x32x16_bf16 v[208:223], a[228:231], v[72:75], v[208:223]
    s_add_u32 s29, s58, 229376
    s_nop 3
    v_max_f32 v160, 0, v160
    v_max_f32 v161, 0, v161
    v_max_f32 v162, 0, v162
    v_max_f32 v163, 0, v163
    v_max_f32 v164, 0, v164
    v_mfma_f32_32x32x16_bf16 v[224:239], a[224:227], v[76:79], v[224:239]
    ds_read_b128 v[108:111], v17 offset:34304
    buffer_load_dwordx4 a[36:39], v3, s[8:11], s39 offen offset:2048
    v_max_f32 v165, 0, v165
    v_mfma_f32_32x32x16_bf16 v[240:255], a[228:231], v[76:79], v[240:255]
    s_lshl1_add_u32 s39, s68, s38
    v_max_f32 v166, 0, v166
    v_max_f32 v167, 0, v167
    v_mul_f32 v160, v160, v176
    v_mul_f32 v161, v161, v177
    s_waitcnt lgkmcnt(6)
    v_mfma_f32_32x32x16_bf16 v[192:207], a[64:67], v[80:83], v[192:207]
    ds_read_b128 v[64:67], v16 offset:8704
    buffer_load_dwordx4 a[40:43], v2, s[8:11], s39 offen offset:0
    v_mul_f32 v162, v162, v178
    v_mfma_f32_32x32x16_bf16 v[208:223], a[68:71], v[80:83], v[208:223]
    v_mul_f32 v163, v163, v179
    v_mul_f32 v164, v164, v180
    v_mul_f32 v165, v165, v181
    v_mul_f32 v166, v166, v182
    v_mul_f32 v167, v167, v183
    v_cvt_pk_bf16_f32 v176, v160, v161
    v_mfma_f32_32x32x16_bf16 v[224:239], a[64:67], v[84:87], v[224:239]
    ds_read_b128 v[68:71], v16 offset:9728
    buffer_load_dwordx4 a[44:47], v3, s[8:11], s39 offen offset:0
    v_cvt_pk_bf16_f32 v177, v162, v163
    v_mfma_f32_32x32x16_bf16 v[240:255], a[68:71], v[84:87], v[240:255]
    v_cvt_pk_bf16_f32 v178, v164, v165
    v_cvt_pk_bf16_f32 v179, v166, v167
    s_waitcnt lgkmcnt(6)
    v_mfma_f32_32x32x16_bf16 v[192:207], a[72:75], v[88:91], v[192:207]
    ds_read_b128 v[72:75], v16 offset:37376
    buffer_store_dwordx4 v[176:179], v1, s[8:11], s29 offen offset:0 sc1
    v_mfma_f32_32x32x16_bf16 v[208:223], a[76:79], v[88:91], v[208:223]
    v_max_f32 v168, 0, v168
    v_max_f32 v169, 0, v169
    v_max_f32 v170, 0, v170
    v_max_f32 v171, 0, v171
    v_max_f32 v172, 0, v172
    v_max_f32 v173, 0, v173
    v_mfma_f32_32x32x16_bf16 v[224:239], a[72:75], v[92:95], v[224:239]
    ds_read_b128 v[76:79], v16 offset:38400
    v_max_f32 v174, 0, v174
    v_max_f32 v175, 0, v175
    v_mul_f32 v168, v168, v184
    v_mul_f32 v169, v169, v185
    v_mul_f32 v170, v170, v186
    v_mfma_f32_32x32x16_bf16 v[240:255], a[76:79], v[92:95], v[240:255]
    v_mul_f32 v171, v171, v187
    v_mul_f32 v172, v172, v188
    v_mul_f32 v173, v173, v189
    v_mul_f32 v174, v174, v190
    v_mul_f32 v175, v175, v191
    s_waitcnt lgkmcnt(6)
    v_mfma_f32_32x32x16_bf16 v[192:207], a[80:83], v[96:99], v[192:207]
    ds_read_b128 v[80:83], v17 offset:8704
    buffer_load_dwordx4 a[48:51], v2, s[8:11], s39 offen offset:2048
    v_cvt_pk_bf16_f32 v180, v168, v169
    v_mfma_f32_32x32x16_bf16 v[208:223], a[84:87], v[96:99], v[208:223]
    v_cvt_pk_bf16_f32 v181, v170, v171
    v_cvt_pk_bf16_f32 v182, v172, v173
    v_cvt_pk_bf16_f32 v183, v174, v175
    v_mfma_f32_32x32x16_bf16 v[224:239], a[80:83], v[100:103], v[224:239]
    ds_read_b128 v[84:87], v17 offset:37376
    buffer_store_dwordx4 v[180:183], v1, s[8:11], s29 offen offset:1024 sc1
    v_mfma_f32_32x32x16_bf16 v[240:255], a[84:87], v[100:103], v[240:255]
    s_waitcnt lgkmcnt(6)
    v_mfma_f32_32x32x16_bf16 v[192:207], a[88:91], v[104:107], v[192:207]
    ds_read_b128 v[88:91], v16 offset:12800
    v_mfma_f32_32x32x16_bf16 v[208:223], a[92:95], v[104:107], v[208:223]
    v_mfma_f32_32x32x16_bf16 v[224:239], a[88:91], v[108:111], v[224:239]
    ds_read_b128 v[92:95], v16 offset:41472
    buffer_load_dwordx4 a[52:55], v3, s[8:11], s39 offen offset:2048
    v_mfma_f32_32x32x16_bf16 v[240:255], a[92:95], v[108:111], v[240:255]
    s_lshl1_add_u32 s39, s69, s38
    s_waitcnt lgkmcnt(6)
    v_mfma_f32_32x32x16_bf16 v[192:207], a[96:99], v[64:67], v[192:207]
    ds_read_b128 v[96:99], v17 offset:12800
    buffer_load_dwordx4 a[56:59], v2, s[8:11], s39 offen offset:0
    v_mfma_f32_32x32x16_bf16 v[208:223], a[100:103], v[64:67], v[208:223]
    v_mfma_f32_32x32x16_bf16 v[224:239], a[96:99], v[68:71], v[224:239]
    ds_read_b128 v[100:103], v17 offset:41472
    buffer_load_dwordx4 a[60:63], v3, s[8:11], s39 offen offset:0
    v_mfma_f32_32x32x16_bf16 v[240:255], a[100:103], v[68:71], v[240:255]
    s_waitcnt lgkmcnt(6)
    v_mfma_f32_32x32x16_bf16 v[192:207], a[104:107], v[72:75], v[192:207]
    ds_read_b128 v[104:107], v16 offset:16896
    buffer_load_dwordx4 a[224:227], v2, s[8:11], s39 offen offset:2048
    v_mfma_f32_32x32x16_bf16 v[208:223], a[108:111], v[72:75], v[208:223]
    v_mfma_f32_32x32x16_bf16 v[224:239], a[104:107], v[76:79], v[224:239]
    ds_read_b128 v[108:111], v16 offset:45568
    buffer_load_dwordx4 a[228:231], v3, s[8:11], s39 offen offset:2048
    v_mfma_f32_32x32x16_bf16 v[240:255], a[108:111], v[76:79], v[240:255]
    s_lshl1_add_u32 s39, s70, s38
    s_waitcnt lgkmcnt(6)
    v_mfma_f32_32x32x16_bf16 v[192:207], a[112:115], v[80:83], v[192:207]
    ds_read_b128 v[64:67], v17 offset:16896
    buffer_load_dwordx4 a[64:67], v2, s[8:11], s39 offen offset:0
    v_cndmask_b32 v144, v144, v176, s[78:79]
    v_mfma_f32_32x32x16_bf16 v[208:223], a[116:119], v[80:83], v[208:223]
    v_cndmask_b32 v145, v145, v177, s[78:79]
    v_cndmask_b32 v146, v146, v178, s[78:79]
    v_cndmask_b32 v147, v147, v179, s[78:79]
    v_cndmask_b32 v148, v148, v180, s[78:79]
    v_cndmask_b32 v149, v149, v181, s[78:79]
    v_cndmask_b32 v150, v150, v182, s[78:79]
    v_mfma_f32_32x32x16_bf16 v[192:207], a[120:123], v[84:87], v[192:207]
    ds_read_b128 v[68:71], v17 offset:45568
    buffer_load_dwordx4 a[68:71], v3, s[8:11], s39 offen offset:0
    v_cndmask_b32 v151, v151, v183, s[78:79]
    v_mfma_f32_32x32x16_bf16 v[208:223], a[124:127], v[84:87], v[208:223]
    s_waitcnt lgkmcnt(6)
    v_mfma_f32_32x32x16_bf16 v[192:207], a[128:131], v[88:91], v[192:207]
    ds_read_b128 v[72:75], v16 offset:20992
    buffer_load_dwordx4 a[72:75], v2, s[8:11], s39 offen offset:2048
    v_mfma_f32_32x32x16_bf16 v[208:223], a[132:135], v[88:91], v[208:223]
    v_mfma_f32_32x32x16_bf16 v[192:207], a[136:139], v[92:95], v[192:207]
    ds_read_b128 v[76:79], v16 offset:49664
    buffer_load_dwordx4 a[76:79], v3, s[8:11], s39 offen offset:2048
    v_mfma_f32_32x32x16_bf16 v[208:223], a[140:143], v[92:95], v[208:223]
    s_lshl1_add_u32 s39, s71, s38
    s_waitcnt lgkmcnt(6)
    v_mfma_f32_32x32x16_bf16 v[192:207], a[144:147], v[96:99], v[192:207]
    ds_read_b128 v[80:83], v17 offset:20992
    buffer_load_dwordx4 a[80:83], v2, s[8:11], s39 offen offset:0
    v_mfma_f32_32x32x16_bf16 v[208:223], a[148:151], v[96:99], v[208:223]
    v_mfma_f32_32x32x16_bf16 v[192:207], a[152:155], v[100:103], v[192:207]
    ds_read_b128 v[84:87], v17 offset:49664
    buffer_load_dwordx4 a[84:87], v3, s[8:11], s39 offen offset:0
    v_mfma_f32_32x32x16_bf16 v[208:223], a[156:159], v[100:103], v[208:223]
    s_waitcnt vmcnt(11)
    buffer_store_dword v35, v36, s[8:11], s56 offen sc1
    s_waitcnt lgkmcnt(6)
    v_mfma_f32_32x32x16_bf16 v[192:207], a[160:163], v[104:107], v[192:207]
    ds_read_b128 v[88:91], v17 offset:9728
    buffer_load_dwordx4 a[88:91], v2, s[8:11], s39 offen offset:2048
    v_mfma_f32_32x32x16_bf16 v[208:223], a[164:167], v[104:107], v[208:223]
    v_mfma_f32_32x32x16_bf16 v[192:207], a[168:171], v[108:111], v[192:207]
    ds_read_b128 v[92:95], v17 offset:38400
    buffer_load_dwordx4 a[92:95], v3, s[8:11], s39 offen offset:2048
    v_mfma_f32_32x32x16_bf16 v[208:223], a[172:175], v[108:111], v[208:223]
    s_lshl1_add_u32 s39, s72, s38
    s_waitcnt lgkmcnt(6)
    v_mfma_f32_32x32x16_bf16 v[192:207], a[176:179], v[64:67], v[192:207]
    ds_read_b128 v[96:99], v16 offset:13824
    buffer_load_dwordx4 a[96:99], v2, s[8:11], s39 offen offset:0
    v_mfma_f32_32x32x16_bf16 v[208:223], a[180:183], v[64:67], v[208:223]
    v_mfma_f32_32x32x16_bf16 v[192:207], a[184:187], v[68:71], v[192:207]
    ds_read_b128 v[100:103], v16 offset:42496
    buffer_load_dwordx4 a[100:103], v3, s[8:11], s39 offen offset:0
    v_mfma_f32_32x32x16_bf16 v[208:223], a[188:191], v[68:71], v[208:223]
    s_waitcnt lgkmcnt(6)
    v_mfma_f32_32x32x16_bf16 v[192:207], a[192:195], v[72:75], v[192:207]
    ds_read_b128 v[104:107], v17 offset:13824
    buffer_load_dwordx4 a[104:107], v2, s[8:11], s39 offen offset:2048
    v_mfma_f32_32x32x16_bf16 v[208:223], a[196:199], v[72:75], v[208:223]
    v_mfma_f32_32x32x16_bf16 v[192:207], a[200:203], v[76:79], v[192:207]
    ds_read_b128 v[108:111], v17 offset:42496
    buffer_load_dwordx4 a[108:111], v3, s[8:11], s39 offen offset:2048
    v_mfma_f32_32x32x16_bf16 v[208:223], a[204:207], v[76:79], v[208:223]
    s_waitcnt lgkmcnt(6)
    v_mfma_f32_32x32x16_bf16 v[192:207], a[208:211], v[80:83], v[192:207]
    ds_read_b128 v[64:67], v16 offset:17920
    v_mfma_f32_32x32x16_bf16 v[208:223], a[212:215], v[80:83], v[208:223]
    v_mfma_f32_32x32x16_bf16 v[192:207], a[216:219], v[84:87], v[192:207]
    ds_read_b128 v[68:71], v16 offset:46592
    v_mfma_f32_32x32x16_bf16 v[208:223], a[220:223], v[84:87], v[208:223]
    s_waitcnt lgkmcnt(6)
    v_mfma_f32_32x32x16_bf16 v[224:239], a[112:115], v[88:91], v[224:239]
    ds_read_b128 v[72:75], v17 offset:17920
    v_mfma_f32_32x32x16_bf16 v[240:255], a[116:119], v[88:91], v[240:255]
    s_add_u32 s29, s58, 114688
    s_nop 4
    v_max_f32 v192, 0, v192
    v_max_f32 v193, 0, v193
    v_max_f32 v194, 0, v194
    v_max_f32 v195, 0, v195
    v_max_f32 v196, 0, v196
    v_mfma_f32_32x32x16_bf16 v[224:239], a[120:123], v[92:95], v[224:239]
    ds_read_b128 v[76:79], v17 offset:46592
    s_lshl1_add_u32 s39, s73, s38
    buffer_load_dwordx4 a[112:115], v2, s[8:11], s39 offen offset:0
    v_mfma_f32_32x32x16_bf16 v[240:255], a[124:127], v[92:95], v[240:255]
    buffer_load_dwordx4 a[116:119], v3, s[8:11], s39 offen offset:0
    v_max_f32 v197, 0, v197
    s_waitcnt lgkmcnt(6)
    v_mfma_f32_32x32x16_bf16 v[224:239], a[128:131], v[96:99], v[224:239]
    ds_read_b128 v[80:83], v16 offset:22016
    v_max_f32 v198, 0, v198
    v_max_f32 v199, 0, v199
    v_mul_f32 v192, v192, v208
    v_mul_f32 v193, v193, v209
    v_mul_f32 v194, v194, v210
    v_mfma_f32_32x32x16_bf16 v[240:255], a[132:135], v[96:99], v[240:255]
    buffer_load_dwordx4 a[120:123], v2, s[8:11], s39 offen offset:2048
    v_mul_f32 v195, v195, v211
    v_mul_f32 v196, v196, v212
    v_mfma_f32_32x32x16_bf16 v[224:239], a[136:139], v[100:103], v[224:239]
    ds_read_b128 v[84:87], v16 offset:50688
    v_mul_f32 v197, v197, v213
    v_mul_f32 v198, v198, v214
    v_mul_f32 v199, v199, v215
    v_cvt_pk_bf16_f32 v208, v192, v193
    v_cvt_pk_bf16_f32 v209, v194, v195
    v_mfma_f32_32x32x16_bf16 v[240:255], a[140:143], v[100:103], v[240:255]
    buffer_load_dwordx4 a[124:127], v3, s[8:11], s39 offen offset:2048
    v_cvt_pk_bf16_f32 v210, v196, v197
    s_waitcnt lgkmcnt(6)
    v_mfma_f32_32x32x16_bf16 v[224:239], a[144:147], v[104:107], v[224:239]
    ds_read_b128 v[88:91], v17 offset:22016
    s_lshl1_add_u32 s39, s74, s38
    v_cvt_pk_bf16_f32 v211, v198, v199
    v_mfma_f32_32x32x16_bf16 v[240:255], a[148:151], v[104:107], v[240:255]
    buffer_store_dwordx4 v[208:211], v1, s[8:11], s29 offen offset:0 sc1
    v_mfma_f32_32x32x16_bf16 v[224:239], a[152:155], v[108:111], v[224:239]
    ds_read_b128 v[92:95], v17 offset:50688
    v_max_f32 v200, 0, v200
    v_max_f32 v201, 0, v201
    v_max_f32 v202, 0, v202
    v_max_f32 v203, 0, v203
    v_max_f32 v204, 0, v204
    v_mfma_f32_32x32x16_bf16 v[240:255], a[156:159], v[108:111], v[240:255]
    v_max_f32 v205, 0, v205
    v_max_f32 v206, 0, v206
    v_max_f32 v207, 0, v207
    v_mul_f32 v200, v200, v216
    v_mul_f32 v201, v201, v217
    s_waitcnt lgkmcnt(6)
    v_mfma_f32_32x32x16_bf16 v[224:239], a[160:163], v[64:67], v[224:239]
    v_mul_f32 v202, v202, v218
    v_mul_f32 v203, v203, v219
    v_mul_f32 v204, v204, v220
    v_mul_f32 v205, v205, v221
    v_mul_f32 v206, v206, v222
    v_mfma_f32_32x32x16_bf16 v[240:255], a[164:167], v[64:67], v[240:255]
    buffer_load_dwordx4 a[128:131], v2, s[8:11], s39 offen offset:0
    v_mul_f32 v207, v207, v223
    v_cvt_pk_bf16_f32 v212, v200, v201
    v_mfma_f32_32x32x16_bf16 v[224:239], a[168:171], v[68:71], v[224:239]
    v_cvt_pk_bf16_f32 v213, v202, v203
    v_cvt_pk_bf16_f32 v214, v204, v205
    v_cvt_pk_bf16_f32 v215, v206, v207
    v_mfma_f32_32x32x16_bf16 v[240:255], a[172:175], v[68:71], v[240:255]
    buffer_store_dwordx4 v[212:215], v1, s[8:11], s29 offen offset:1024 sc1
    s_waitcnt lgkmcnt(4)
    v_mfma_f32_32x32x16_bf16 v[224:239], a[176:179], v[72:75], v[224:239]
    buffer_load_dwordx4 a[132:135], v3, s[8:11], s39 offen offset:0
    v_mfma_f32_32x32x16_bf16 v[240:255], a[180:183], v[72:75], v[240:255]
    buffer_load_dwordx4 a[136:139], v2, s[8:11], s39 offen offset:2048
    v_mfma_f32_32x32x16_bf16 v[224:239], a[184:187], v[76:79], v[224:239]
    buffer_load_dwordx4 a[140:143], v3, s[8:11], s39 offen offset:2048
    v_mfma_f32_32x32x16_bf16 v[240:255], a[188:191], v[76:79], v[240:255]
    s_lshl1_add_u32 s39, s75, s38
    buffer_load_dwordx4 a[144:147], v2, s[8:11], s39 offen offset:0
    s_waitcnt lgkmcnt(3)
    v_mfma_f32_32x32x16_bf16 v[224:239], a[192:195], v[80:83], v[224:239]
    buffer_load_dword v37, v34, s[8:11], s56 offen sc1
    v_mfma_f32_32x32x16_bf16 v[240:255], a[196:199], v[80:83], v[240:255]
    buffer_load_dwordx4 a[148:151], v3, s[8:11], s39 offen offset:0
    s_waitcnt lgkmcnt(2)
    v_mfma_f32_32x32x16_bf16 v[224:239], a[200:203], v[84:87], v[224:239]
    buffer_load_dwordx4 a[152:155], v2, s[8:11], s39 offen offset:2048
    v_mfma_f32_32x32x16_bf16 v[240:255], a[204:207], v[84:87], v[240:255]
    buffer_load_dwordx4 a[156:159], v3, s[8:11], s39 offen offset:2048
    s_waitcnt lgkmcnt(1)
    v_mfma_f32_32x32x16_bf16 v[224:239], a[208:211], v[88:91], v[224:239]
    v_mfma_f32_32x32x16_bf16 v[240:255], a[212:215], v[88:91], v[240:255]
    s_waitcnt lgkmcnt(0)
    v_mfma_f32_32x32x16_bf16 v[224:239], a[216:219], v[92:95], v[224:239]
    v_mfma_f32_32x32x16_bf16 v[240:255], a[220:223], v[92:95], v[240:255]
    s_add_u32 s29, s58, 344064
    s_nop 9
    v_max_f32 v224, 0, v224
    v_max_f32 v225, 0, v225
    v_max_f32 v226, 0, v226
    v_max_f32 v227, 0, v227
    v_max_f32 v228, 0, v228
    v_max_f32 v229, 0, v229
    v_max_f32 v230, 0, v230
    v_max_f32 v231, 0, v231
    v_pk_mul_f32 v[224:225], v[224:225], v[240:241]
    v_pk_mul_f32 v[226:227], v[226:227], v[242:243]
    v_pk_mul_f32 v[228:229], v[228:229], v[244:245]
    v_pk_mul_f32 v[230:231], v[230:231], v[246:247]
    v_cvt_pk_bf16_f32 v240, v224, v225
    v_cvt_pk_bf16_f32 v241, v226, v227
    v_cvt_pk_bf16_f32 v242, v228, v229
    v_cvt_pk_bf16_f32 v243, v230, v231
    buffer_store_dwordx4 v[240:243], v1, s[8:11], s29 offen offset:0 sc1
    v_max_f32 v232, 0, v232
    v_max_f32 v233, 0, v233
    v_max_f32 v234, 0, v234
    v_max_f32 v235, 0, v235
    v_max_f32 v236, 0, v236
    v_max_f32 v237, 0, v237
    v_max_f32 v238, 0, v238
    v_max_f32 v239, 0, v239
    v_pk_mul_f32 v[232:233], v[232:233], v[248:249]
    v_pk_mul_f32 v[234:235], v[234:235], v[250:251]
    v_pk_mul_f32 v[236:237], v[236:237], v[252:253]
    v_pk_mul_f32 v[238:239], v[238:239], v[254:255]
    v_cvt_pk_bf16_f32 v244, v232, v233
    v_cvt_pk_bf16_f32 v245, v234, v235
    v_cvt_pk_bf16_f32 v246, v236, v237
    v_cvt_pk_bf16_f32 v247, v238, v239
    buffer_store_dwordx4 v[244:247], v1, s[8:11], s29 offen offset:1024 sc1
    s_waitcnt vmcnt(5)
    v_cmp_ne_u32 vcc, 1, v37
    s_nop 1
    s_cbranch_vccnz K2_PA_S
K2_PA_OK:
    s_add_u32 s47, s62, s65
    buffer_load_dwordx4 v[128:131], v1, s[8:11], s47 offen offset:0 sc1
    buffer_load_dwordx4 v[132:135], v1, s[8:11], s47 offen offset:1024 sc1
    s_add_u32 s47, s62, s66
    buffer_load_dwordx4 v[136:139], v1, s[8:11], s47 offen offset:0 sc1
    buffer_load_dwordx4 v[140:143], v1, s[8:11], s47 offen offset:1024 sc1
    s_add_u32 s47, s62, s67
    buffer_load_dwordx4 v[152:155], v1, s[8:11], s47 offen offset:0 sc1
    buffer_load_dwordx4 v[156:159], v1, s[8:11], s47 offen offset:1024 sc1
    s_add_u32 s47, s62, s68
    buffer_load_dwordx4 v[160:163], v1, s[8:11], s47 offen offset:0 sc1
    buffer_load_dwordx4 v[164:167], v1, s[8:11], s47 offen offset:1024 sc1
    v_cndmask_b32 v64, v208, v240, s[78:79]
    v_cndmask_b32 v65, v209, v241, s[78:79]
    v_cndmask_b32 v66, v210, v242, s[78:79]
    v_cndmask_b32 v67, v211, v243, s[78:79]
    v_cndmask_b32 v68, v212, v244, s[78:79]
    v_cndmask_b32 v69, v213, v245, s[78:79]
    v_cndmask_b32 v70, v214, v246, s[78:79]
    v_cndmask_b32 v71, v215, v247, s[78:79]
    v_mfma_f32_32x32x16_bf16 v[208:223], a[236:239], v[144:147], 0
    v_mfma_f32_32x32x16_bf16 v[192:207], a[232:235], v[144:147], 0
    v_mfma_f32_32x32x16_bf16 v[208:223], a[244:247], v[148:151], v[208:223]
    v_mfma_f32_32x32x16_bf16 v[192:207], a[240:243], v[148:151], v[192:207]
    s_waitcnt vmcnt(8)
    buffer_store_dword v35, v36, s[8:11], s57 offen sc1
    v_mfma_f32_32x32x16_bf16 v[240:255], a[236:239], v[64:67], 0
    v_mfma_f32_32x32x16_bf16 v[224:239], a[232:235], v[64:67], 0
    v_mfma_f32_32x32x16_bf16 v[240:255], a[244:247], v[68:71], v[240:255]
    v_mfma_f32_32x32x16_bf16 v[224:239], a[240:243], v[68:71], v[224:239]
    s_waitcnt vmcnt(8)
    v_mfma_f32_32x32x16_bf16 v[208:223], a[252:255], v[128:131], v[208:223]
    s_add_u32 s47, s62, s69
    buffer_load_dwordx4 v[168:171], v1, s[8:11], s47 offen offset:0 sc1
    buffer_load_dwordx4 v[172:175], v1, s[8:11], s47 offen offset:1024 sc1
    s_add_u32 s47, s62, s70
    buffer_load_dwordx4 v[176:179], v1, s[8:11], s47 offen offset:0 sc1
    buffer_load_dwordx4 v[180:183], v1, s[8:11], s47 offen offset:1024 sc1
    s_add_u32 s47, s62, s71
    buffer_load_dwordx4 v[184:187], v1, s[8:11], s47 offen offset:0 sc1
    buffer_load_dwordx4 v[188:191], v1, s[8:11], s47 offen offset:1024 sc1
    v_mfma_f32_32x32x16_bf16 v[192:207], a[248:251], v[128:131], v[192:207]
    s_waitcnt vmcnt(13)
    v_mfma_f32_32x32x16_bf16 v[208:223], a[4:7], v[132:135], v[208:223]
    s_add_u32 s47, s62, s72
    buffer_load_dwordx4 v[72:75], v1, s[8:11], s47 offen offset:0 sc1
    v_mfma_f32_32x32x16_bf16 v[192:207], a[0:3], v[132:135], v[192:207]
    s_waitcnt vmcnt(13)
    v_mfma_f32_32x32x16_bf16 v[208:223], a[12:15], v[136:139], v[208:223]
    buffer_load_dwordx4 v[76:79], v1, s[8:11], s47 offen offset:1024 sc1
    v_mfma_f32_32x32x16_bf16 v[192:207], a[8:11], v[136:139], v[192:207]
    s_waitcnt vmcnt(13)
    v_mfma_f32_32x32x16_bf16 v[208:223], a[20:23], v[140:143], v[208:223]
    s_add_u32 s47, s62, s73
    buffer_load_dwordx4 v[80:83], v1, s[8:11], s47 offen offset:0 sc1
    v_mfma_f32_32x32x16_bf16 v[192:207], a[16:19], v[140:143], v[192:207]
    s_waitcnt vmcnt(13)
    v_mfma_f32_32x32x16_bf16 v[208:223], a[28:31], v[152:155], v[208:223]
    buffer_load_dwordx4 v[84:87], v1, s[8:11], s47 offen offset:1024 sc1
    v_mfma_f32_32x32x16_bf16 v[192:207], a[24:27], v[152:155], v[192:207]
    s_waitcnt vmcnt(13)
    v_mfma_f32_32x32x16_bf16 v[208:223], a[36:39], v[156:159], v[208:223]
    s_add_u32 s47, s62, s74
    buffer_load_dwordx4 v[88:91], v1, s[8:11], s47 offen offset:0 sc1
    v_mfma_f32_32x32x16_bf16 v[192:207], a[32:35], v[156:159], v[192:207]
    s_waitcnt vmcnt(13)
    v_mfma_f32_32x32x16_bf16 v[208:223], a[44:47], v[160:163], v[208:223]
    buffer_load_dwordx4 v[92:95], v1, s[8:11], s47 offen offset:1024 sc1
    v_mfma_f32_32x32x16_bf16 v[192:207], a[40:43], v[160:163], v[192:207]
    s_waitcnt vmcnt(13)
    v_mfma_f32_32x32x16_bf16 v[208:223], a[52:55], v[164:167], v[208:223]
    s_add_u32 s47, s62, s75
    buffer_load_dwordx4 v[96:99], v1, s[8:11], s47 offen offset:0 sc1
    v_mfma_f32_32x32x16_bf16 v[192:207], a[48:51], v[164:167], v[192:207]
    s_waitcnt vmcnt(12)
    v_mfma_f32_32x32x16_bf16 v[208:223], a[60:63], v[168:171], v[208:223]
    buffer_load_dwordx4 v[100:103], v1, s[8:11], s47 offen offset:1024 sc1
    s_lshl1_add_u32 s39, s76, s38
    buffer_load_dwordx4 a[160:163], v2, s[8:11], s39 offen offset:0
    buffer_load_dwordx4 a[164:167], v3, s[8:11], s39 offen offset:0
    v_mfma_f32_32x32x16_bf16 v[192:207], a[56:59], v[168:171], v[192:207]
    s_waitcnt vmcnt(14)
    v_mfma_f32_32x32x16_bf16 v[208:223], a[228:231], v[172:175], v[208:223]
    v_mfma_f32_32x32x16_bf16 v[192:207], a[224:227], v[172:175], v[192:207]
    s_waitcnt vmcnt(13)
    v_mfma_f32_32x32x16_bf16 v[208:223], a[68:71], v[176:179], v[208:223]
    s_add_u32 s47, s62, s76
    buffer_load_dwordx4 v[104:107], v1, s[8:11], s47 offen offset:0 sc1
    v_mfma_f32_32x32x16_bf16 v[192:207], a[64:67], v[176:179], v[192:207]
    s_waitcnt vmcnt(13)
    v_mfma_f32_32x32x16_bf16 v[208:223], a[76:79], v[180:183], v[208:223]
    buffer_load_dword v37, v34, s[8:11], s57 offen sc1
    v_mfma_f32_32x32x16_bf16 v[192:207], a[72:75], v[180:183], v[192:207]
    s_waitcnt vmcnt(13)
    v_mfma_f32_32x32x16_bf16 v[208:223], a[84:87], v[184:187], v[208:223]
    buffer_load_dwordx4 a[168:171], v2, s[8:11], s39 offen offset:2048
    buffer_load_dwordx4 a[172:175], v3, s[8:11], s39 offen offset:2048
    v_mfma_f32_32x32x16_bf16 v[192:207], a[80:83], v[184:187], v[192:207]
    s_waitcnt vmcnt(14)
    v_mfma_f32_32x32x16_bf16 v[208:223], a[92:95], v[188:191], v[208:223]
    v_mfma_f32_32x32x16_bf16 v[192:207], a[88:91], v[188:191], v[192:207]
    s_waitcnt vmcnt(13)
    v_mfma_f32_32x32x16_bf16 v[208:223], a[100:103], v[72:75], v[208:223]
    buffer_load_dwordx4 v[108:111], v1, s[8:11], s47 offen offset:1024 sc1
    v_mfma_f32_32x32x16_bf16 v[192:207], a[96:99], v[72:75], v[192:207]
    s_waitcnt vmcnt(13)
    v_mfma_f32_32x32x16_bf16 v[208:223], a[108:111], v[76:79], v[208:223]
    s_lshl1_add_u32 s39, s77, s38
    buffer_load_dwordx4 a[176:179], v2, s[8:11], s39 offen offset:0
    buffer_load_dwordx4 a[180:183], v3, s[8:11], s39 offen offset:0
    v_mfma_f32_32x32x16_bf16 v[192:207], a[104:107], v[76:79], v[192:207]
    s_waitcnt vmcnt(14)
    v_mfma_f32_32x32x16_bf16 v[208:223], a[116:119], v[80:83], v[208:223]
    v_mfma_f32_32x32x16_bf16 v[192:207], a[112:115], v[80:83], v[192:207]
    s_waitcnt vmcnt(13)
    v_mfma_f32_32x32x16_bf16 v[208:223], a[124:127], v[84:87], v[208:223]
    s_add_u32 s47, s62, s77
    buffer_load_dwordx4 v[112:115], v1, s[8:11], s47 offen offset:0 sc1
    v_mfma_f32_32x32x16_bf16 v[192:207], a[120:123], v[84:87], v[192:207]
    v_add_u32 v32, 133632, v5
    v_add_u32 v33, 133632, v6
    s_waitcnt vmcnt(13)
    v_mfma_f32_32x32x16_bf16 v[208:223], a[132:135], v[88:91], v[208:223]
    buffer_load_dwordx4 a[184:187], v2, s[8:11], s39 offen offset:2048
    buffer_load_dwordx4 a[188:191], v3, s[8:11], s39 offen offset:2048
    v_add_u32 v38, 133632, v7
    v_mfma_f32_32x32x16_bf16 v[192:207], a[128:131], v[88:91], v[192:207]
    v_add_u32 v39, 133632, v14
    s_waitcnt vmcnt(14)
    v_mfma_f32_32x32x16_bf16 v[208:223], a[140:143], v[92:95], v[208:223]
    v_lshlrev_b32 v20, 16, v56
    v_mfma_f32_32x32x16_bf16 v[192:207], a[136:139], v[92:95], v[192:207]
    v_and_b32 v21, 0xffff0000, v56
    s_waitcnt vmcnt(13)
    v_mfma_f32_32x32x16_bf16 v[208:223], a[148:151], v[96:99], v[208:223]
    buffer_load_dwordx4 v[116:119], v1, s[8:11], s47 offen offset:1024 sc1
    v_lshlrev_b32 v22, 16, v57
    v_and_b32 v23, 0xffff0000, v57
    v_mfma_f32_32x32x16_bf16 v[192:207], a[144:147], v[96:99], v[192:207]
    v_lshlrev_b32 v24, 16, v58
    s_waitcnt vmcnt(13)
    v_mfma_f32_32x32x16_bf16 v[208:223], a[156:159], v[100:103], v[208:223]
    s_waitcnt vmcnt(9)
    v_cmp_ne_u32 vcc, 1, v37
    s_nop 1
    s_cbranch_vccnz K2_PB_S
K2_PB_OK:
    s_add_u32 s47, s63, s65
    buffer_load_dwordx4 v[120:123], v1, s[8:11], s47 offen offset:0 sc1
    buffer_load_dwordx4 v[124:127], v1, s[8:11], s47 offen offset:1024 sc1
    s_add_u32 s47, s63, s66
    buffer_load_dwordx4 v[144:147], v1, s[8:11], s47 offen offset:0 sc1
    buffer_load_dwordx4 v[148:151], v1, s[8:11], s47 offen offset:1024 sc1
    s_add_u32 s47, s63, s67
    buffer_load_dwordx4 v[64:67], v1, s[8:11], s47 offen offset:0 sc1
    v_and_b32 v25, 0xffff0000, v58
    v_mfma_f32_32x32x16_bf16 v[192:207], a[152:155], v[100:103], v[192:207]
    v_lshlrev_b32 v26, 16, v59
    v_mfma_f32_32x32x16_bf16 v[208:223], a[164:167], v[104:107], v[208:223]
    v_and_b32 v27, 0xffff0000, v59
    v_mfma_f32_32x32x16_bf16 v[192:207], a[160:163], v[104:107], v[192:207]
    s_waitcnt vmcnt(11)
    v_mfma_f32_32x32x16_bf16 v[208:223], a[172:175], v[108:111], v[208:223]
    buffer_load_dwordx4 v[68:71], v1, s[8:11], s47 offen offset:1024 sc1
    s_add_u32 s47, s63, s68
    buffer_load_dwordx4 v[128:131], v1, s[8:11], s47 offen offset:0 sc1
    buffer_load_dwordx4 v[132:135], v1, s[8:11], s47 offen offset:1024 sc1
    v_mfma_f32_32x32x16_bf16 v[192:207], a[168:171], v[108:111], v[192:207]
    s_waitcnt vmcnt(11)
    v_mfma_f32_32x32x16_bf16 v[208:223], a[180:183], v[112:115], v[208:223]
    s_add_u32 s47, s63, s69
    buffer_load_dwordx4 v[136:139], v1, s[8:11], s47 offen offset:0 sc1
    buffer_load_dwordx4 v[140:143], v1, s[8:11], s47 offen offset:1024 sc1
    s_add_u32 s47, s63, s70
    buffer_load_dwordx4 v[152:155], v1, s[8:11], s47 offen offset:0 sc1
    v_mfma_f32_32x32x16_bf16 v[192:207], a[176:179], v[112:115], v[192:207]
    s_waitcnt vmcnt(11)
    v_mfma_f32_32x32x16_bf16 v[208:223], a[188:191], v[116:119], v[208:223]
    buffer_load_dwordx4 v[156:159], v1, s[8:11], s47 offen offset:1024 sc1
    s_add_u32 s47, s63, s71
    buffer_load_dwordx4 v[160:163], v1, s[8:11], s47 offen offset:0 sc1
    buffer_load_dwordx4 v[164:167], v1, s[8:11], s47 offen offset:1024 sc1
    v_mfma_f32_32x32x16_bf16 v[192:207], a[184:187], v[116:119], v[192:207]
    s_waitcnt vmcnt(13)
    v_mfma_f32_32x32x16_bf16 v[240:255], a[252:255], v[120:123], v[240:255]
    s_add_u32 s47, s63, s72
    buffer_load_dwordx4 v[168:171], v1, s[8:11], s47 offen offset:0 sc1
    v_mfma_f32_32x32x16_bf16 v[224:239], a[248:251], v[120:123], v[224:239]
    s_nop 6
    ds_write_b128 v33, v[200:203] offset:2048
    ds_write_b128 v33, v[204:207] offset:3072
    ds_write_b128 v32, v[208:211] offset:0
    s_waitcnt vmcnt(13)
    v_mfma_f32_32x32x16_bf16 v[240:255], a[4:7], v[124:127], v[240:255]
    buffer_load_dwordx4 v[172:175], v1, s[8:11], s47 offen offset:1024 sc1
    ds_write_b128 v32, v[212:215] offset:1024
    ds_write_b128 v38, v[216:219] offset:4096
    v_mfma_f32_32x32x16_bf16 v[224:239], a[0:3], v[124:127], v[224:239]
    ds_write_b128 v38, v[220:223] offset:5120
    v_fma_f32 v20, v192, v40, v20
    s_waitcnt vmcnt(13)
    v_mfma_f32_32x32x16_bf16 v[240:255], a[12:15], v[144:147], v[240:255]
    s_add_u32 s47, s63, s73
    buffer_load_dwordx4 v[176:179], v1, s[8:11], s47 offen offset:0 sc1
    v_fma_f32 v21, v193, v41, v21
    v_fma_f32 v22, v194, v42, v22
    v_fma_f32 v23, v195, v43, v23
    v_mfma_f32_32x32x16_bf16 v[224:239], a[8:11], v[144:147], v[224:239]
    v_fma_f32 v24, v196, v44, v24
    v_fma_f32 v25, v197, v45, v25
    s_waitcnt vmcnt(13)
    v_mfma_f32_32x32x16_bf16 v[240:255], a[20:23], v[148:151], v[240:255]
    buffer_load_dwordx4 v[180:183], v1, s[8:11], s47 offen offset:1024 sc1
    v_fma_f32 v26, v198, v46, v26
    v_fma_f32 v27, v199, v47, v27
    v_mfma_f32_32x32x16_bf16 v[224:239], a[16:19], v[148:151], v[224:239]
    s_waitcnt vmcnt(13)
    v_mfma_f32_32x32x16_bf16 v[240:255], a[28:31], v[64:67], v[240:255]
    s_add_u32 s47, s63, s74
    buffer_load_dwordx4 v[184:187], v1, s[8:11], s47 offen offset:0 sc1
    v_mfma_f32_32x32x16_bf16 v[224:239], a[24:27], v[64:67], v[224:239]
    s_waitcnt vmcnt(13)
    v_mfma_f32_32x32x16_bf16 v[240:255], a[36:39], v[68:71], v[240:255]
    buffer_load_dwordx4 v[188:191], v1, s[8:11], s47 offen offset:1024 sc1
    v_mfma_f32_32x32x16_bf16 v[224:239], a[32:35], v[68:71], v[224:239]
    s_waitcnt lgkmcnt(0)
    s_barrier
    s_waitcnt vmcnt(13)
    v_mfma_f32_32x32x16_bf16 v[240:255], a[44:47], v[128:131], v[240:255]
    s_add_u32 s47, s63, s75
    buffer_load_dwordx4 v[72:75], v1, s[8:11], s47 offen offset:0 sc1
    ds_read_b128 v[200:203], v39 offset:0
    ds_read_b128 v[204:207], v39 offset:1024
    v_mfma_f32_32x32x16_bf16 v[224:239], a[40:43], v[128:131], v[224:239]
    ds_read_b128 v[208:211], v39 offset:2048
    ds_read_b128 v[212:215], v39 offset:3072
    s_waitcnt vmcnt(13)
    v_mfma_f32_32x32x16_bf16 v[240:255], a[52:55], v[132:135], v[240:255]
    buffer_load_dwordx4 v[76:79], v1, s[8:11], s47 offen offset:1024 sc1
    ds_read_b128 v[216:219], v39 offset:4096
    ds_read_b128 v[220:223], v39 offset:5120
    v_mfma_f32_32x32x16_bf16 v[224:239], a[48:51], v[132:135], v[224:239]
    s_waitcnt vmcnt(13)
    v_mfma_f32_32x32x16_bf16 v[240:255], a[60:63], v[136:139], v[240:255]
    s_add_u32 s47, s63, s76
    buffer_load_dwordx4 v[80:83], v1, s[8:11], s47 offen offset:0 sc1
    v_mfma_f32_32x32x16_bf16 v[224:239], a[56:59], v[136:139], v[224:239]
    s_waitcnt vmcnt(13)
    v_mfma_f32_32x32x16_bf16 v[240:255], a[228:231], v[140:143], v[240:255]
    buffer_load_dwordx4 v[84:87], v1, s[8:11], s47 offen offset:1024 sc1
    v_mfma_f32_32x32x16_bf16 v[224:239], a[224:227], v[140:143], v[224:239]
    s_waitcnt lgkmcnt(4)
    v_fma_f32 v20, v200, v40, v20
    v_fma_f32 v21, v201, v41, v21
    s_waitcnt vmcnt(13)
    v_mfma_f32_32x32x16_bf16 v[240:255], a[68:71], v[152:155], v[240:255]
    s_add_u32 s47, s63, s77
    buffer_load_dwordx4 v[88:91], v1, s[8:11], s47 offen offset:0 sc1
    v_fma_f32 v22, v202, v42, v22
    v_fma_f32 v23, v203, v43, v23
    v_fma_f32 v24, v204, v44, v24
    v_mfma_f32_32x32x16_bf16 v[224:239], a[64:67], v[152:155], v[224:239]
    v_fma_f32 v25, v205, v45, v25
    v_fma_f32 v26, v206, v46, v26
    v_fma_f32 v27, v207, v47, v27
    s_waitcnt vmcnt(13)
    v_mfma_f32_32x32x16_bf16 v[240:255], a[76:79], v[156:159], v[240:255]
    buffer_load_dwordx4 v[92:95], v1, s[8:11], s47 offen offset:1024 sc1
    s_waitcnt lgkmcnt(2)
    v_fma_f32 v20, v208, v40, v20
    v_fma_f32 v21, v209, v41, v21
    v_mfma_f32_32x32x16_bf16 v[224:239], a[72:75], v[156:159], v[224:239]
    v_fma_f32 v22, v210, v42, v22
    v_fma_f32 v23, v211, v43, v23
    v_fma_f32 v24, v212, v44, v24
    s_waitcnt vmcnt(13)
    v_mfma_f32_32x32x16_bf16 v[240:255], a[84:87], v[160:163], v[240:255]
    v_fma_f32 v25, v213, v45, v25
    v_fma_f32 v26, v214, v46, v26
    v_mfma_f32_32x32x16_bf16 v[224:239], a[80:83], v[160:163], v[224:239]
    v_fma_f32 v27, v215, v47, v27
    s_waitcnt lgkmcnt(0)
    v_fma_f32 v20, v216, v40, v20
    s_waitcnt vmcnt(12)
    v_mfma_f32_32x32x16_bf16 v[240:255], a[92:95], v[164:167], v[240:255]
    v_fma_f32 v21, v217, v41, v21
    v_fma_f32 v22, v218, v42, v22
    v_fma_f32 v23, v219, v43, v23
    v_mfma_f32_32x32x16_bf16 v[224:239], a[88:91], v[164:167], v[224:239]
    v_fma_f32 v24, v220, v44, v24
    v_fma_f32 v25, v221, v45, v25
    v_fma_f32 v26, v222, v46, v26
    s_waitcnt vmcnt(11)
    v_mfma_f32_32x32x16_bf16 v[240:255], a[100:103], v[168:171], v[240:255]
    v_fma_f32 v27, v223, v47, v27
    v_cvt_pk_bf16_f32 v28, v20, v21
    v_cvt_pk_bf16_f32 v29, v22, v23
    v_mfma_f32_32x32x16_bf16 v[224:239], a[96:99], v[168:171], v[224:239]
    v_cvt_pk_bf16_f32 v30, v24, v25
    v_cvt_pk_bf16_f32 v31, v26, v27
    s_nop 0
    v_permlane32_swap_b32 v28, v30
    s_waitcnt vmcnt(10)
    v_mfma_f32_32x32x16_bf16 v[240:255], a[108:111], v[172:175], v[240:255]
    v_permlane32_swap_b32 v29, v31
    buffer_store_dwordx4 v[28:31], v19, s[12:15], s60 offen sc1
    v_mfma_f32_32x32x16_bf16 v[224:239], a[104:107], v[172:175], v[224:239]
    s_waitcnt vmcnt(10)
    v_mfma_f32_32x32x16_bf16 v[240:255], a[116:119], v[176:179], v[240:255]
    v_mfma_f32_32x32x16_bf16 v[224:239], a[112:115], v[176:179], v[224:239]
    v_lshlrev_b32 v20, 16, v8
    v_and_b32 v21, 0xffff0000, v8
    s_waitcnt vmcnt(9)
    v_mfma_f32_32x32x16_bf16 v[240:255], a[124:127], v[180:183], v[240:255]
    v_lshlrev_b32 v22, 16, v9
    v_mfma_f32_32x32x16_bf16 v[224:239], a[120:123], v[180:183], v[224:239]
    v_and_b32 v23, 0xffff0000, v9
    s_waitcnt vmcnt(8)
    v_mfma_f32_32x32x16_bf16 v[240:255], a[132:135], v[184:187], v[240:255]
    v_lshlrev_b32 v24, 16, v10
    v_and_b32 v25, 0xffff0000, v10
    v_lshlrev_b32 v26, 16, v11
    s_waitcnt vmcnt(7)
    v_mfma_f32_32x32x16_bf16 v[240:255], a[140:143], v[188:191], v[240:255]
    v_and_b32 v27, 0xffff0000, v11
    s_waitcnt vmcnt(6)
    v_mfma_f32_32x32x16_bf16 v[240:255], a[148:151], v[72:75], v[240:255]
    s_waitcnt vmcnt(5)
    v_mfma_f32_32x32x16_bf16 v[240:255], a[156:159], v[76:79], v[240:255]
    s_waitcnt vmcnt(4)
    v_mfma_f32_32x32x16_bf16 v[240:255], a[164:167], v[80:83], v[240:255]
    s_waitcnt vmcnt(3)
    v_mfma_f32_32x32x16_bf16 v[240:255], a[172:175], v[84:87], v[240:255]
    s_waitcnt vmcnt(2)
    v_mfma_f32_32x32x16_bf16 v[240:255], a[180:183], v[88:91], v[240:255]
    s_waitcnt vmcnt(1)
    v_mfma_f32_32x32x16_bf16 v[240:255], a[188:191], v[92:95], v[240:255]
    v_mfma_f32_32x32x16_bf16 v[224:239], a[128:131], v[184:187], v[224:239]
    v_mfma_f32_32x32x16_bf16 v[224:239], a[136:139], v[188:191], v[224:239]
    v_mfma_f32_32x32x16_bf16 v[224:239], a[144:147], v[72:75], v[224:239]
    v_mfma_f32_32x32x16_bf16 v[224:239], a[152:155], v[76:79], v[224:239]
    s_nop 7
    ds_write_b128 v5, v[240:243] offset:0
    v_mfma_f32_32x32x16_bf16 v[224:239], a[160:163], v[80:83], v[224:239]
    ds_write_b128 v5, v[244:247] offset:1024
    v_mfma_f32_32x32x16_bf16 v[224:239], a[168:171], v[84:87], v[224:239]
    ds_write_b128 v7, v[248:251] offset:4096
    v_mfma_f32_32x32x16_bf16 v[224:239], a[176:179], v[88:91], v[224:239]
    ds_write_b128 v7, v[252:255] offset:5120
    v_mfma_f32_32x32x16_bf16 v[224:239], a[184:187], v[92:95], v[224:239]
    s_nop 11
    ds_write_b128 v6, v[232:235] offset:2048
    ds_write_b128 v6, v[236:239] offset:3072
    v_pk_fma_f32 v[20:21], v[224:225], v[48:49], v[20:21]
    v_pk_fma_f32 v[22:23], v[226:227], v[50:51], v[22:23]
    v_pk_fma_f32 v[24:25], v[228:229], v[52:53], v[24:25]
    v_pk_fma_f32 v[26:27], v[230:231], v[54:55], v[26:27]
    s_waitcnt lgkmcnt(0)
    s_barrier
    ds_read_b128 v[232:235], v14 offset:0
    ds_read_b128 v[236:239], v14 offset:1024
    ds_read_b128 v[240:243], v14 offset:2048
    ds_read_b128 v[244:247], v14 offset:3072
    ds_read_b128 v[248:251], v14 offset:4096
    ds_read_b128 v[252:255], v14 offset:5120
    s_waitcnt lgkmcnt(4)
    v_pk_fma_f32 v[20:21], v[232:233], v[48:49], v[20:21]
    v_pk_fma_f32 v[22:23], v[234:235], v[50:51], v[22:23]
    v_pk_fma_f32 v[24:25], v[236:237], v[52:53], v[24:25]
    v_pk_fma_f32 v[26:27], v[238:239], v[54:55], v[26:27]
    s_waitcnt lgkmcnt(2)
    v_pk_fma_f32 v[20:21], v[240:241], v[48:49], v[20:21]
    v_pk_fma_f32 v[22:23], v[242:243], v[50:51], v[22:23]
    v_pk_fma_f32 v[24:25], v[244:245], v[52:53], v[24:25]
    v_pk_fma_f32 v[26:27], v[246:247], v[54:55], v[26:27]
    s_waitcnt lgkmcnt(0)
    v_pk_fma_f32 v[20:21], v[248:249], v[48:49], v[20:21]
    v_pk_fma_f32 v[22:23], v[250:251], v[50:51], v[22:23]
    v_pk_fma_f32 v[24:25], v[252:253], v[52:53], v[24:25]
    v_pk_fma_f32 v[26:27], v[254:255], v[54:55], v[26:27]
    v_cvt_pk_bf16_f32 v28, v20, v21
    v_cvt_pk_bf16_f32 v29, v22, v23
    v_cvt_pk_bf16_f32 v30, v24, v25
    v_cvt_pk_bf16_f32 v31, v26, v27
    s_nop 0
    v_permlane32_swap_b32 v28, v30
    v_permlane32_swap_b32 v29, v31
    buffer_store_dwordx4 v[28:31], v19, s[12:15], s61 offen
K2_END:
    s_endpgm
K2_P1_S:
    s_mov_b32 s36, 0
K2_P1_L:
    buffer_load_dword v37, v32, s[8:11], s35 offen sc1
    s_add_u32 s36, s36, 1
    s_waitcnt vmcnt(0)
    v_cmp_ne_u32 vcc, 1, v37
    s_cmp_gt_u32 s36, 400000
    s_cbranch_scc1 K2_P1_OK
    s_nop 1
    s_cbranch_vccnz K2_P1_L
    s_branch K2_P1_OK
K2_PA_S:
    s_waitcnt vmcnt(0)
    buffer_store_dword v35, v36, s[8:11], s57 offen sc1
    s_mov_b32 s36, 0
K2_PA_L:
    buffer_load_dword v37, v34, s[8:11], s56 offen sc1
    s_add_u32 s36, s36, 1
    s_waitcnt vmcnt(0)
    v_cmp_ne_u32 vcc, 1, v37
    s_cmp_gt_u32 s36, 400000
    s_cbranch_scc1 K2_PA_OK
    s_nop 1
    s_cbranch_vccnz K2_PA_L
    s_branch K2_PA_OK
K2_PB_S:
    s_mov_b32 s36, 0
K2_PB_L:
    buffer_load_dword v37, v34, s[8:11], s57 offen sc1
    s_add_u32 s36, s36, 1
    s_waitcnt vmcnt(0)
    v_cmp_ne_u32 vcc, 1, v37
    s_cmp_gt_u32 s36, 400000
    s_cbranch_scc1 K2_PB_OK
    s_nop 1
    s_cbranch_vccnz K2_PB_L
    s_branch K2_PB_OK
.p2align 8
.type k1_tbl,@object
k1_tbl:
.quad 0x0,0x3f803f803f803f80,0xbf20bedebe640000,0x3f483f673f7a3f80,0xbf7abf48bede0000,0x3e643f203f673f80,0xbf67bf7abf200000,0xbede3e643f483f80
.quad 0xbedebf7abf480000,0xbf67be643f203f80,0x3e64bf48bf670000,0xbf7abf203ede3f80,0x3f48bedebf7a0000,0xbf20bf673e643f80,0x3f800000bf800000,0xbf8000003f80
.quad 0x3f483edebf7a0000,0x3f20bf67be643f80,0x3e643f48bf670000,0x3f7abf20bede3f80,0xbede3f7abf480000,0x3f67be64bf203f80,0xbf673f7abf200000,0x3ede3e64bf483f80
.quad 0xbf7a3f48bede0000,0xbe643f20bf673f80,0xbf203edebe640000,0xbf483f67bf7a3f80,0x0,0xbf803f80bf803f80,0x3f20bede3e640000,0xbf483f67bf7a3f80
.quad 0x0,0x3f803f803f803f80,0xbf80bf7abf67bf48,0x3e643ede3f20,0xbedebf48bf7a,0xbf80bf67bf20be64,0x3f803f483e64bede,0xbf20bf7abf67
.quad 0x3f483f7a3ede,0x3f803f20be64bf67,0xbf80bede3f203f7a,0x3f673f48be64,0xbf7abede3f48,0xbf80be643f673f20,0x3f800000bf800000,0xbf8000003f80
.quad 0x3f7abedebf48,0x3f80be64bf673f20,0xbf803ede3f20bf7a,0x3f67bf48be64,0xbf483f7abede,0xbf803f203e64bf67,0x3f80bf483e643ede,0xbf203f7abf67
.quad 0x3edebf483f7a,0x3f80bf673f20be64,0xbf803f7abf673f48,0x3e64bede3f20,0x0,0xbf803f80bf803f80,0x3f80bf7a3f67bf48,0x3e64bede3f20
.quad 0x0,0x3f803f803f803f80,0xbf20bf48bf67bf7a,0xbf48bf20bedebe64,0x3f7a3f7a3f483ede,0x3e64be64bf20bf67,0xbf67bede3e643f48,0x3ede3f673f7a3f20
.quad 0x3edebedebf7abf48,0xbf67bf67be643f20,0x3e643f7a3f20bede,0x3f7a3e64bf48bf67,0xbf48bf483ede3f7a,0xbf203f203f67be64,0x3f800000bf800000,0xbf8000003f80
.quad 0xbf483f483edebf7a,0x3f203f20bf67be64,0x3e64bf7a3f203ede,0xbf7a3e643f48bf67,0x3ede3edebf7a3f48,0x3f67bf673e643f20,0xbf673ede3e64bf48,0xbede3f67bf7a3f20
.quad 0x3f7abf7a3f48bede,0xbe64be643f20bf67,0xbf203f48bf673f7a,0x3f48bf203edebe64,0x0,0xbf803f80bf803f80,0x3f20bf483f67bf7a,0x3f48bf203edebe64
.quad 0x0,0x3f803f803f803f80,0x3e640000be64bede,0xbf7abf80bf7abf67,0xbede00003ede3f48,0x3f673f803f673f20,0x3f200000bf20bf7a,0xbf48bf80bf48be64
.quad 0xbf4800003f483f7a,0x3f203f803f20be64,0x3f670000bf67bf48,0xbedebf80bede3f20,0xbf7a00003f7a3ede,0x3e643f803e64bf67,0x3f800000bf800000,0xbf8000003f80
.quad 0xbf7a00003f7abede,0xbe643f80be64bf67,0x3f670000bf673f48,0x3edebf803ede3f20,0xbf4800003f48bf7a,0xbf203f80bf20be64,0x3f200000bf203f7a,0x3f48bf803f48be64
.quad 0xbede00003edebf48,0xbf673f80bf673f20,0x3e640000be643ede,0x3f7abf803f7abf67,0x0,0xbf803f80bf803f80,0xbe6400003e64bede,0x3f7abf803f7abf67
.quad 0x0,0x0,0x3f203ede3e640000,0x3f673f483f203ede,0x3f7a3f483ede0000,0xbf48bf7abf7abf48,0x3f673f7a3f200000,0xbe643ede3f673f7a
.quad 0x3ede3f7a3f480000,0x3f7a3edebedebf7a,0xbe643f483f670000,0xbf20bf7abe643f48,0xbf483ede3f7a0000,0xbede3f483f48bede,0xbf8000003f800000,0x3f800000bf800000
.quad 0xbf48bede3f7a0000,0xbedebf483f483ede,0xbe64bf483f670000,0xbf203f7abe64bf48,0x3edebf7a3f480000,0x3f7abedebede3f7a,0x3f67bf7a3f200000,0xbe64bede3f67bf7a
.quad 0x3f7abf483ede0000,0xbf483f7abf7a3f48,0x3f20bede3e640000,0x3f67bf483f20bede,0x0,0x0,0xbf203edebe640000,0xbf673f48bf203ede
.quad 0x0,0x0,0x3f803f7a3f673f48,0x3f673f7a3f803f7a,0x3ede3f483f7a,0x3f483ede0000bede,0xbf80bf48be643ede,0xbe64bf48bf80bf48
.quad 0xbf48bf7abede,0xbf7abf4800003f48,0x3f803edebf20bf7a,0xbf203ede3f803ede,0x3f7a3edebf48,0x3ede3f7a0000bf7a,0xbf8000003f800000,0x3f800000bf800000
.quad 0xbf7a3ede3f48,0x3edebf7a00003f7a,0x3f80bedebf203f7a,0xbf20bede3f80bede,0x3f48bf7a3ede,0xbf7a3f480000bf48,0xbf803f48be64bede,0xbe643f48bf803f48
.quad 0xbede3f48bf7a,0x3f48bede00003ede,0x3f80bf7a3f67bf48,0x3f67bf7a3f80bf7a,0x0,0x0,0xbf803f7abf673f48,0xbf673f7abf803f7a
.quad 0x0,0x0,0x3f203f483f673f7a,0x3e643ede3f203f48,0xbf7abf7abf48bede,0x3ede3f483f7a3f7a,0x3f673edebe64bf48,0x3f203f7a3f673ede
.quad 0xbede3ede3f7a3f48,0x3f483f7a3edebede,0xbe64bf7abf203ede,0x3f673f48be64bf7a,0x3f483f48bedebf7a,0x3f7a3edebf48bf48,0xbf8000003f800000,0x3f800000bf800000
.quad 0x3f48bf48bede3f7a,0x3f7abedebf483f48,0xbe643f7abf20bede,0x3f67bf48be643f7a,0xbedebede3f7abf48,0x3f48bf7a3ede3ede,0x3f67bedebe643f48,0x3f20bf7a3f67bede
.quad 0xbf7a3f7abf483ede,0x3edebf483f7abf7a,0x3f20bf483f67bf7a,0x3e64bede3f20bf48,0x0,0x0,0xbf203f48bf673f7a,0xbe643edebf203f48
.quad 0x0,0x0,0xbe6400003e643ede,0x0,0x3ede0000bedebf48,0x0,0xbf2000003f203f7a,0x0
.quad 0x3f480000bf48bf7a,0x0,0xbf6700003f673f48,0x0,0x3f7a0000bf7abede,0x0,0xbf8000003f800000,0x0
.quad 0x3f7a0000bf7a3ede,0x0,0xbf6700003f67bf48,0x0,0x3f480000bf483f7a,0x0,0xbf2000003f20bf7a,0x0
.quad 0x3ede0000bede3f48,0x0,0xbe6400003e64bede,0x0,0x0,0x0,0x3e640000be643ede,0x0
.quad 0x3f803f803f803f80,0x0,0xbedebf20bf48bf67,0xbf67bf48bf20bede,0xbf20be643e643f20,0x3f483f7a3f7a3f48,0x3f7a3f673edebe64,0x3e64bedebf67bf7a
.quad 0xbe64bf67bf67be64,0xbf7abede3ede3f7a,0xbf483e643f7a3f20,0x3f203f7a3e64bf48,0x3f673f20bf20bf67,0x3edebf48bf483ede,0xbf8000003f80,0xbf8000003f800000
.quad 0xbf673f203f20bf67,0x3ede3f48bf48bede,0x3f483e64bf7a3f20,0x3f20bf7a3e643f48,0x3e64bf673f67be64,0xbf7a3ede3edebf7a,0xbf7a3f67bedebe64,0x3e643edebf673f7a
.quad 0x3f20be64be643f20,0x3f48bf7a3f7abf48,0x3edebf203f48bf67,0xbf673f48bf203ede,0xbf803f80bf803f80,0x0,0x3edebf203f48bf67,0x3f67bf483f20bede
.quad 0x3f803f803f803f80,0x0,0x3ede3e640000be64,0xbf67bf7abf80bf7a,0xbf20bf67bf80bf67,0xbf48bede00003ede,0xbf7abf2000003f20,0x3e643f483f803f48
.quad 0xbe643f203f803f20,0x3f7a3f480000bf48,0x3f483f670000bf67,0x3f20bedebf80bede,0x3f67be64bf80be64,0xbedebf7a00003f7a,0xbf8000003f80,0xbf8000003f800000
.quad 0xbf67be643f80be64,0xbede3f7a0000bf7a,0xbf483f670000bf67,0x3f203edebf803ede,0x3e643f20bf803f20,0x3f7abf4800003f48,0x3f7abf2000003f20,0x3e64bf483f80bf48
.quad 0x3f20bf673f80bf67,0xbf483ede0000bede,0xbede3e640000be64,0xbf673f7abf803f7a,0xbf803f80bf803f80,0x0,0xbede3e640000be64,0x3f67bf7a3f80bf7a
.quad 0x3f803f803f803f80,0x0,0x3f7a3f673f483f20,0xbe64bedebf20bf48,0x3f673f203e64be64,0xbedebf48bf7abf7a,0x3f483e64bedebf67,0xbf20bf7abf67bede
.quad 0x3f20be64bf67bf67,0xbf48bf7abede3ede,0x3edebf20bf7abe64,0xbf67bf483e643f7a,0x3e64bf67bf203f20,0xbf7abede3f483f48,0xbf8000003f80,0xbf8000003f800000
.quad 0xbe64bf673f203f20,0xbf7a3ede3f48bf48,0xbedebf203f7abe64,0xbf673f483e64bf7a,0xbf20be643f67bf67,0xbf483f7abedebede,0xbf483e643edebf67,0xbf203f7abf673ede
.quad 0xbf673f20be64be64,0xbede3f48bf7a3f7a,0xbf7a3f67bf483f20,0xbe643edebf203f48,0xbf803f80bf803f80,0x0,0xbf7a3f67bf483f20,0x3e64bede3f20bf48
.quad 0x0,0x0,0x0,0x0,0x0,0x0,0x8000000000000000,0x0
.quad 0x8000800000000000,0x0,0x8000800000000000,0x8000000000000000,0x8000800000000000,0x8000000000000000,0x800000000000,0x8000000000000000
.quad 0x800080000000,0x8000800000000000,0x800080000000,0x8000800000000000,0x800080000000,0x800000000000,0x80000000,0x800000000000
.quad 0x8000000080000000,0x800000000000,0x8000000080000000,0x800000000000,0x8000000080000000,0x0,0x8000000080000000,0x8000000080000000
.quad 0x3f7abf483ede0000,0xbe643f20bf673f80,0x3f67bf7a3f200000,0x3ede3e64bf483f80,0x3edebf7a3f480000,0x3f67be64bf203f80,0xbe64bf483f670000,0x3f7abf20bede3f80
.quad 0xbf48bede3f7a0000,0x3f20bf67be643f80,0xbf8000003f800000,0xbf8000003f80,0xbf483ede3f7a0000,0xbf20bf673e643f80,0xbe643f483f670000,0xbf7abf203ede3f80
.quad 0x3ede3f7a3f480000,0xbf67be643f203f80,0x3f673f7a3f200000,0xbede3e643f483f80,0x3f7a3f483ede0000,0x3e643f203f673f80,0x3f203ede3e640000,0x3f483f673f7a3f80
.quad 0x0,0x0,0x0,0x0,0x0,0x0,0x0,0x8000000000000000
.quad 0xbede3f48bf7a,0x3f80bf673f20be64,0xbf803f48be64bede,0xbf203f7abf67,0x3f48bf7a3ede,0xbf803f203e64bf67,0x3f80bedebf203f7a,0x3f67bf48be64
.quad 0xbf7a3ede3f48,0x3f80be64bf673f20,0xbf8000003f800000,0xbf8000003f80,0x3f7a3edebf48,0xbf80be643f673f20,0x3f803edebf20bf7a,0x3f673f48be64
.quad 0xbf48bf7abede,0x3f803f20be64bf67,0xbf80bf48be643ede,0xbf20bf7abf67,0x3ede3f483f7a,0xbf80bf67bf20be64,0x3f803f7a3f673f48,0x3e643ede3f20
.quad 0x0,0x0,0x0,0x0,0x0,0x8000800080008000,0x0,0x800080008000
.quad 0xbf7a3f7abf483ede,0xbe64be643f20bf67,0x3f67bedebe643f48,0xbede3f67bf7a3f20,0xbedebede3f7abf48,0x3f67bf673e643f20,0xbe643f7abf20bede,0xbf7a3e643f48bf67
.quad 0x3f48bf48bede3f7a,0x3f203f20bf67be64,0xbf8000003f800000,0xbf8000003f80,0x3f483f48bedebf7a,0xbf203f203f67be64,0xbe64bf7abf203ede,0x3f7a3e64bf48bf67
.quad 0xbede3ede3f7a3f48,0xbf67bf67be643f20,0x3f673edebe64bf48,0x3ede3f673f7a3f20,0xbf7abf7abf48bede,0x3e64be64bf20bf67,0x3f203f483f673f7a,0xbf48bf20bedebe64
.quad 0x0,0x0,0x0,0x8000800080008000,0x0,0x800080008000,0x0,0x0
.quad 0x3ede0000bede3f48,0xbf673f80bf673f20,0xbf2000003f20bf7a,0x3f48bf803f48be64,0x3f480000bf483f7a,0xbf203f80bf20be64,0xbf6700003f67bf48,0x3edebf803ede3f20
.quad 0x3f7a0000bf7a3ede,0xbe643f80be64bf67,0xbf8000003f800000,0xbf8000003f80,0x3f7a0000bf7abede,0x3e643f803e64bf67,0xbf6700003f673f48,0xbedebf80bede3f20
.quad 0x3f480000bf48bf7a,0x3f203f803f20be64,0xbf2000003f203f7a,0xbf48bf80bf48be64,0x3ede0000bedebf48,0x3f673f803f673f20,0xbe6400003e643ede,0xbf7abf80bf7abf67
.quad 0x0,0x0,0x0,0x8000800080008000,0x0,0x0,0x0,0x8000800080008000
.quad 0xbf7a3f48bede0000,0x3f48bf7a3f7abf48,0xbf673f7abf200000,0x3e643edebf673f7a,0xbede3f7abf480000,0xbf7a3ede3edebf7a,0x3e643f48bf670000,0x3f20bf7a3e643f48
.quad 0x3f483edebf7a0000,0x3ede3f48bf48bede,0x3f800000bf800000,0xbf8000003f800000,0x3f48bedebf7a0000,0x3edebf48bf483ede,0x3e64bf48bf670000,0x3f203f7a3e64bf48
.quad 0xbedebf7abf480000,0xbf7abede3ede3f7a,0xbf67bf7abf200000,0x3e64bedebf67bf7a,0xbf7abf48bede0000,0x3f483f7a3f7a3f48,0xbf20bedebe640000,0xbf67bf48bf20bede
.quad 0x0,0x0,0x0,0x0,0x0,0x0,0x0,0x0
.quad 0x3edebf483f7a,0xbf483ede0000bede,0x3f80bf483e643ede,0x3e64bf483f80bf48,0xbf483f7abede,0x3f7abf4800003f48,0xbf803ede3f20bf7a,0x3f203edebf803ede
.quad 0x3f7abedebf48,0xbede3f7a0000bf7a,0x3f800000bf800000,0xbf8000003f800000,0xbf7abede3f48,0xbedebf7a00003f7a,0xbf80bede3f203f7a,0x3f20bedebf80bede
.quad 0x3f483f7a3ede,0x3f7a3f480000bf48,0x3f803f483e64bede,0x3e643f483f803f48,0xbedebf48bf7a,0xbf48bede00003ede,0xbf80bf7abf67bf48,0xbf67bf7abf80bf7a
.quad 0x0,0x0,0x0,0x0,0x0,0x0,0x8000800080000000,0x0
.quad 0x3f7abf7a3f48bede,0xbede3f48bf7a3f7a,0xbf673ede3e64bf48,0xbf203f7abf673ede,0x3ede3edebf7a3f48,0xbf483f7abedebede,0x3e64bf7a3f203ede,0xbf673f483e64bf7a
.quad 0xbf483f483edebf7a,0xbf7a3ede3f48bf48,0x3f800000bf800000,0xbf8000003f800000,0xbf48bf483ede3f7a,0xbf7abede3f483f48,0x3e643f7a3f20bede,0xbf67bf483e643f7a
.quad 0x3edebedebf7abf48,0xbf48bf7abede3ede,0xbf67bede3e643f48,0xbf20bf7abf67bede,0x3f7a3f7a3f483ede,0xbedebf48bf7abf7a,0xbf20bf48bf67bf7a,0xbe64bedebf20bf48
.quad 0x0,0x0,0x0,0x0,0x8000800080008000,0x0,0x80008000,0x0
.quad 0xbede00003edebf48,0x0,0x3f200000bf203f7a,0x0,0xbf4800003f48bf7a,0x0,0x3f670000bf673f48,0x0
.quad 0xbf7a00003f7abede,0x0,0x3f800000bf800000,0x0,0xbf7a00003f7a3ede,0x0,0x3f670000bf67bf48,0x0
.quad 0xbf4800003f483f7a,0x0,0x3f200000bf20bf7a,0x0,0xbede00003ede3f48,0x0,0x3e640000be64bede,0x0
.quad 0x0,0x0,0x8000000000000000,0x0,0x80008000,0x0,0x8000000000000000,0x0
.quad 0x3f20be64be643f20,0xbf483f7abf7a3f48,0xbf7a3f67bedebe64,0xbe64bede3f67bf7a,0x3e64bf673f67be64,0x3f7abedebede3f7a,0x3f483e64bf7a3f20,0xbf203f7abe64bf48
.quad 0xbf673f203f20bf67,0xbedebf483f483ede,0xbf8000003f80,0x3f800000bf800000,0x3f673f20bf20bf67,0xbede3f483f48bede,0xbf483e643f7a3f20,0xbf20bf7abe643f48
.quad 0xbe64bf67bf67be64,0x3f7a3edebedebf7a,0x3f7a3f673edebe64,0xbe643ede3f673f7a,0xbf20be643e643f20,0xbf48bf7abf7abf48,0xbedebf20bf48bf67,0x3f673f483f203ede
.quad 0x0,0x0,0x8000800080008000,0x8000800080008000,0x8000800000000000,0x0,0x8000,0x800080008000
.quad 0x3f20bf673f80bf67,0x3f48bede00003ede,0x3f7abf2000003f20,0xbe643f48bf803f48,0x3e643f20bf803f20,0xbf7a3f480000bf48,0xbf483f670000bf67,0xbf20bede3f80bede
.quad 0xbf67be643f80be64,0x3edebf7a00003f7a,0xbf8000003f80,0x3f800000bf800000,0x3f67be64bf80be64,0x3ede3f7a0000bf7a,0x3f483f670000bf67,0xbf203ede3f803ede
.quad 0xbe643f203f803f20,0xbf7abf4800003f48,0xbf7abf2000003f20,0xbe64bf48bf80bf48,0xbf20bf67bf80bf67,0x3f483ede0000bede,0x3ede3e640000be64,0x3f673f7a3f803f7a
.quad 0x0,0x0,0x8000,0x8000800080008000,0x8000800080008000,0x8000800000000000,0x8000800000000000,0x0
.quad 0xbf673f20be64be64,0x3edebf483f7abf7a,0xbf483e643edebf67,0x3f20bf7a3f67bede,0xbf20be643f67bf67,0x3f48bf7a3ede3ede,0xbedebf203f7abe64,0x3f67bf48be643f7a
.quad 0xbe64bf673f203f20,0x3f7abedebf483f48,0xbf8000003f80,0x3f800000bf800000,0x3e64bf67bf203f20,0x3f7a3edebf48bf48,0x3edebf20bf7abe64,0x3f673f48be64bf7a
.quad 0x3f20be64bf67bf67,0x3f483f7a3edebede,0x3f483e64bedebf67,0x3f203f7a3f673ede,0x3f673f203e64be64,0x3ede3f483f7a3f7a,0x3f7a3f673f483f20,0x3e643ede3f203f48
.quad 0x0,0x0,0x0,0x8000800080008000,0x8000,0x8000800080008000,0x80008000,0x8000800080008000
.quad 0x8000000080000000,0x8000000080000000,0x80000000,0x8000000080000000,0x800080000000,0x8000000080000000,0x800080000000,0x80000000
.quad 0x800080000000,0x80000000,0x800000000000,0x80000000,0x8000800000000000,0x800080000000,0x8000800000000000,0x800080000000
.quad 0x8000800000000000,0x8000800080000000,0x8000000000000000,0x8000800080000000,0x0,0x8000800080000000,0x0,0x8000800080000000
.quad 0x0,0x0,0x0,0x0,0x0,0x0,0x8000000000000000,0x0
.size k1_tbl, 6144
.p2align 8
.type k2_tbl,@object
k2_tbl:
.quad 0x3f803f003f00,0x3f8000003f80,0xbf803f003f00,0xbf353f353f353f35,0x3f803f003f00,0xbf8000003f800000,0xbf803f003f00,0xbf35bf353f35bf35
.quad 0x3f803f003f00,0xbf800000bf80,0xbf803f003f00,0x3f35bf35bf35bf35,0x3f803f003f00,0x3f800000bf800000,0xbf803f003f00,0x3f353f35bf353f35
.quad 0x3f803f003f00,0x3f8000003f80,0xbf803f003f00,0xbf353f353f353f35,0x3f803f003f00,0xbf8000003f800000,0xbf803f003f00,0xbf35bf353f35bf35
.quad 0x3f803f003f00,0xbf800000bf80,0xbf803f003f00,0x3f35bf35bf35bf35,0x3f803f003f00,0x3f800000bf800000,0xbf803f003f00,0x3f353f35bf353f35
.quad 0x3f8000003f80,0x3f8000003f80,0xbe483f7b3e483f7b,0xbf553f0e3f553f0e,0xbec43f6d3ec43f6d,0xbf6dbec43f6dbec4,0xbf0e3f553f0e3f55,0xbe48bf7b3e48bf7b
.quad 0xbf353f353f353f35,0x3f35bf35bf35bf35,0xbf553f0e3f553f0e,0x3f7b3e48bf7b3e48,0xbf6d3ec43f6d3ec4,0x3ec43f6dbec43f6d,0xbf7b3e483f7b3e48,0xbf0e3f553f0e3f55
.quad 0xbf8000003f800000,0xbf8000003f800000,0xbf7bbe483f7bbe48,0xbf0ebf553f0ebf55,0xbf6dbec43f6dbec4,0x3ec4bf6dbec4bf6d,0xbf55bf0e3f55bf0e,0x3f7bbe48bf7bbe48
.quad 0xbf35bf353f35bf35,0x3f353f35bf353f35,0xbf0ebf553f0ebf55,0xbe483f7b3e483f7b,0xbec4bf6d3ec4bf6d,0xbf6d3ec43f6d3ec4,0xbe48bf7b3e48bf7b,0xbf55bf0e3f55bf0e
.quad 0x3f8000003f80,0x3f8000003f80,0xbec43f6d3ec43f6d,0xbf6d3ec43f6d3ec4,0xbf353f353f353f35,0xbf35bf353f35bf35,0xbf6d3ec43f6d3ec4,0x3ec4bf6dbec4bf6d
.quad 0xbf8000003f800000,0x3f800000bf800000,0xbf6dbec43f6dbec4,0x3ec43f6dbec43f6d,0xbf35bf353f35bf35,0xbf353f353f353f35,0xbec4bf6d3ec4bf6d,0xbf6dbec43f6dbec4
.quad 0xbf800000bf80,0xbf800000bf80,0x3ec4bf6dbec4bf6d,0x3f6dbec4bf6dbec4,0x3f35bf35bf35bf35,0x3f353f35bf353f35,0x3f6dbec4bf6dbec4,0xbec43f6d3ec43f6d
.quad 0x3f800000bf800000,0xbf8000003f800000,0x3f6d3ec4bf6d3ec4,0xbec4bf6d3ec4bf6d,0x3f353f35bf353f35,0x3f35bf35bf35bf35,0x3ec43f6dbec43f6d,0x3f6d3ec4bf6d3ec4
.quad 0x3f8000003f80,0x3f8000003f80,0xbf0e3f553f0e3f55,0xbf7b3e483f7b3e48,0xbf6d3ec43f6d3ec4,0xbec4bf6d3ec4bf6d,0xbf7bbe483f7bbe48,0x3f55bf0ebf55bf0e
.quad 0xbf35bf353f35bf35,0x3f353f35bf353f35,0xbe48bf7b3e48bf7b,0xbf0e3f553f0e3f55,0x3ec4bf6dbec4bf6d,0xbf6dbec43f6dbec4,0x3f55bf0ebf55bf0e,0x3e48bf7bbe48bf7b
.quad 0x3f800000bf800000,0x3f800000bf800000,0x3f553f0ebf553f0e,0x3e483f7bbe483f7b,0x3ec43f6dbec43f6d,0xbf6d3ec43f6d3ec4,0xbe483f7b3e483f7b,0xbf0ebf553f0ebf55
.quad 0xbf353f353f353f35,0x3f35bf35bf35bf35,0xbf7b3e483f7b3e48,0x3f553f0ebf553f0e,0xbf6dbec43f6dbec4,0xbec43f6d3ec43f6d,0xbf0ebf553f0ebf55,0xbf7bbe483f7bbe48
.quad 0x3f8000003f80,0x3f8000003f80,0xbf8000003f800000,0xbf35bf353f35bf35,0xbf800000bf80,0x3f800000bf800000,0x3f800000bf800000,0xbf353f353f353f35
.quad 0x3f8000003f80,0xbf800000bf80,0xbf8000003f800000,0x3f353f35bf353f35,0xbf800000bf80,0xbf8000003f800000,0x3f800000bf800000,0x3f35bf35bf35bf35
.quad 0x3f8000003f80,0x3f8000003f80,0xbf8000003f800000,0xbf35bf353f35bf35,0xbf800000bf80,0x3f800000bf800000,0x3f800000bf800000,0xbf353f353f353f35
.quad 0x3f8000003f80,0xbf800000bf80,0xbf8000003f800000,0x3f353f35bf353f35,0xbf800000bf80,0xbf8000003f800000,0x3f800000bf800000,0x3f35bf35bf35bf35
.quad 0x3f8000003f80,0x3f8000003f80,0xbf7bbe483f7bbe48,0xbf0ebf553f0ebf55,0x3ec4bf6dbec4bf6d,0x3f6d3ec4bf6d3ec4,0x3f553f0ebf553f0e,0xbf7b3e483f7b3e48
.quad 0xbf353f353f353f35,0x3f35bf35bf35bf35,0xbf0ebf553f0ebf55,0xbe483f7b3e483f7b,0x3f6dbec4bf6dbec4,0xbec4bf6d3ec4bf6d,0x3e483f7bbe483f7b,0x3f553f0ebf553f0e
.quad 0xbf8000003f800000,0xbf8000003f800000,0x3e48bf7bbe48bf7b,0x3f55bf0ebf55bf0e,0x3f6d3ec4bf6d3ec4,0xbec43f6d3ec43f6d,0xbf0e3f553f0e3f55,0xbe48bf7b3e48bf7b
.quad 0xbf35bf353f35bf35,0x3f353f35bf353f35,0x3f55bf0ebf55bf0e,0xbf7bbe483f7bbe48,0x3ec43f6dbec43f6d,0x3f6dbec4bf6dbec4,0xbf7b3e483f7b3e48,0xbf0e3f553f0e3f55
.quad 0x3f8000003f80,0x3f8000003f80,0xbf6dbec43f6dbec4,0xbec4bf6d3ec4bf6d,0x3f35bf35bf35bf35,0x3f353f35bf353f35,0x3ec43f6dbec43f6d,0xbf6dbec43f6dbec4
.quad 0xbf8000003f800000,0x3f800000bf800000,0x3ec4bf6dbec4bf6d,0xbf6d3ec43f6d3ec4,0x3f353f35bf353f35,0x3f35bf35bf35bf35,0xbf6d3ec43f6d3ec4,0xbec43f6d3ec43f6d
.quad 0xbf800000bf80,0xbf800000bf80,0x3f6d3ec4bf6d3ec4,0x3ec43f6dbec43f6d,0xbf353f353f353f35,0xbf35bf353f35bf35,0xbec4bf6d3ec4bf6d,0x3f6d3ec4bf6d3ec4
.quad 0x3f800000bf800000,0xbf8000003f800000,0xbec43f6d3ec43f6d,0x3f6dbec4bf6dbec4,0xbf35bf353f35bf35,0xbf353f353f353f35,0x3f6dbec4bf6dbec4,0x3ec4bf6dbec4bf6d
.quad 0x3f8000003f80,0x3f8000003f80,0xbf55bf0e3f55bf0e,0xbe48bf7b3e48bf7b,0x3f6dbec4bf6dbec4,0x3ec43f6dbec43f6d,0xbe483f7b3e483f7b,0xbf0ebf553f0ebf55
.quad 0xbf35bf353f35bf35,0x3f353f35bf353f35,0x3f7bbe48bf7bbe48,0xbf55bf0e3f55bf0e,0xbec43f6d3ec43f6d,0x3f6d3ec4bf6d3ec4,0xbf0ebf553f0ebf55,0xbf7bbe483f7bbe48
.quad 0x3f800000bf800000,0x3f800000bf800000,0xbf0e3f553f0e3f55,0xbf7b3e483f7b3e48,0xbec4bf6d3ec4bf6d,0x3f6dbec4bf6dbec4,0x3f7b3e48bf7b3e48,0xbf553f0e3f553f0e
.quad 0xbf353f353f353f35,0x3f35bf35bf35bf35,0xbe48bf7b3e48bf7b,0xbf0e3f553f0e3f55,0x3f6d3ec4bf6d3ec4,0x3ec4bf6dbec4bf6d,0xbf553f0e3f553f0e,0xbe483f7b3e483f7b
.quad 0x3f8000003f80,0x3f8000003f80,0xbdc93f7f3dc93f7f,0xbf463f223f463f22,0xbe483f7b3e483f7b,0xbf7bbe483f7bbe48,0xbe953f753e953f75,0xbef1bf623ef1bf62
.quad 0xbec43f6d3ec43f6d,0x3ec4bf6dbec4bf6d,0xbef13f623ef13f62,0x3f75be95bf75be95,0xbf0e3f553f0e3f55,0x3f553f0ebf553f0e,0xbf223f463f223f46,0x3dc93f7fbdc93f7f
.quad 0xbf353f353f353f35,0xbf353f353f353f35,0xbf463f223f463f22,0xbf7fbdc93f7fbdc9,0xbf553f0e3f553f0e,0xbf0ebf553f0ebf55,0xbf623ef13f623ef1,0x3e95bf75be95bf75
.quad 0xbf6d3ec43f6d3ec4,0x3f6dbec4bf6dbec4,0xbf753e953f753e95,0x3f623ef1bf623ef1,0xbf7b3e483f7b3e48,0x3e483f7bbe483f7b,0xbf7f3dc93f7f3dc9,0xbf223f463f223f46
.quad 0x3f8000003f80,0x3f8000003f80,0xbe953f753e953f75,0xbf623ef13f623ef1,0xbf0e3f553f0e3f55,0xbf55bf0e3f55bf0e,0xbf463f223f463f22,0x3dc9bf7fbdc9bf7f
.quad 0xbf6d3ec43f6d3ec4,0x3f6dbec4bf6dbec4,0xbf7f3dc93f7f3dc9,0x3f463f22bf463f22,0xbf7bbe483f7bbe48,0xbe483f7b3e483f7b,0xbf62bef13f62bef1,0xbf753e953f753e95
.quad 0xbf35bf353f35bf35,0xbf35bf353f35bf35,0xbef1bf623ef1bf62,0x3e95bf75be95bf75,0xbe48bf7b3e48bf7b,0x3f7bbe48bf7bbe48,0x3dc9bf7fbdc9bf7f,0x3f223f46bf223f46
.quad 0x3ec4bf6dbec4bf6d,0xbec43f6d3ec43f6d,0x3f22bf46bf22bf46,0xbf7f3dc93f7f3dc9,0x3f55bf0ebf55bf0e,0xbf0ebf553f0ebf55,0x3f75be95bf75be95,0x3ef1bf62bef1bf62
.quad 0x3f8000003f80,0x3f8000003f80,0xbef13f623ef13f62,0xbf753e953f753e95,0xbf553f0e3f553f0e,0xbf0ebf553f0ebf55,0xbf7f3dc93f7f3dc9,0x3f22bf46bf22bf46
.quad 0xbf6dbec43f6dbec4,0x3f6d3ec4bf6d3ec4,0xbf22bf463f22bf46,0xbdc93f7f3dc93f7f,0xbe48bf7b3e48bf7b,0xbf7b3e483f7b3e48,0x3e95bf75be95bf75,0xbef1bf623ef1bf62
.quad 0x3f35bf35bf35bf35,0x3f35bf35bf35bf35,0x3f75be95bf75be95,0x3f623ef1bf623ef1,0x3f7b3e48bf7b3e48,0xbe483f7b3e483f7b,0x3f463f22bf463f22,0xbf7f3dc93f7f3dc9
.quad 0x3ec43f6dbec43f6d,0xbec4bf6d3ec4bf6d,0xbdc93f7f3dc93f7f,0x3f46bf22bf46bf22,0xbf0e3f553f0e3f55,0x3f553f0ebf553f0e,0xbf623ef13f623ef1,0xbe953f753e953f75
.quad 0x3f8000003f80,0x3f8000003f80,0xbf223f463f223f46,0xbf7f3dc93f7f3dc9,0xbf7b3e483f7b3e48,0xbe48bf7b3e48bf7b,0xbf62bef13f62bef1,0x3f75be95bf75be95
.quad 0xbec4bf6d3ec4bf6d,0x3ec43f6dbec43f6d,0x3e95bf75be95bf75,0xbf623ef13f623ef1,0x3f55bf0ebf55bf0e,0xbf0ebf553f0ebf55,0x3f7f3dc9bf7f3dc9,0x3f46bf22bf46bf22
.quad 0x3f353f35bf353f35,0x3f353f35bf353f35,0x3dc93f7fbdc93f7f,0xbf223f463f223f46,0xbf0e3f553f0e3f55,0xbf55bf0e3f55bf0e,0xbf753e953f753e95,0x3ef1bf62bef1bf62
.quad 0xbf6dbec43f6dbec4,0x3f6d3ec4bf6d3ec4,0xbef1bf623ef1bf62,0xbe953f753e953f75,0x3e48bf7bbe48bf7b,0xbf7bbe483f7bbe48,0x3f46bf22bf46bf22,0x3dc9bf7fbdc9bf7f
.quad 0x3f8000003f80,0x3f8000003f80,0xbf7fbdc93f7fbdc9,0xbf22bf463f22bf46,0x3e48bf7bbe48bf7b,0x3f7b3e48bf7b3e48,0x3f753e95bf753e95,0xbf623ef13f623ef1
.quad 0xbec43f6d3ec43f6d,0x3ec4bf6dbec4bf6d,0xbf62bef13f62bef1,0x3e953f75be953f75,0x3f0ebf55bf0ebf55,0xbf55bf0e3f55bf0e,0x3f463f22bf463f22,0x3f7fbdc9bf7fbdc9
.quad 0xbf353f353f353f35,0xbf353f353f353f35,0xbf22bf463f22bf46,0x3dc9bf7fbdc9bf7f,0x3f55bf0ebf55bf0e,0x3f0e3f55bf0e3f55,0x3ef13f62bef13f62,0xbf75be953f75be95
.quad 0xbf6d3ec43f6d3ec4,0x3f6dbec4bf6dbec4,0xbe95bf753e95bf75,0xbef13f623ef13f62,0x3f7bbe48bf7bbe48,0xbe48bf7b3e48bf7b,0x3dc93f7fbdc93f7f,0x3f463f22bf463f22
.quad 0x3f8000003f80,0x3f8000003f80,0xbf75be953f75be95,0xbef1bf623ef1bf62,0x3f0ebf55bf0ebf55,0x3f553f0ebf553f0e,0x3f223f46bf223f46,0xbf7fbdc93f7fbdc9
.quad 0xbf6d3ec43f6d3ec4,0x3f6dbec4bf6dbec4,0xbdc9bf7f3dc9bf7f,0xbf223f463f223f46,0x3f7b3e48bf7b3e48,0x3e48bf7bbe48bf7b,0xbef13f623ef13f62,0x3e953f75be953f75
.quad 0xbf35bf353f35bf35,0xbf35bf353f35bf35,0x3f62bef1bf62bef1,0x3f753e95bf753e95,0x3e483f7bbe483f7b,0xbf7b3e483f7b3e48,0xbf7fbdc93f7fbdc9,0x3f46bf22bf46bf22
.quad 0x3ec4bf6dbec4bf6d,0xbec43f6d3ec43f6d,0x3f463f22bf463f22,0xbdc9bf7f3dc9bf7f,0xbf553f0e3f553f0e,0x3f0e3f55bf0e3f55,0xbe95bf753e95bf75,0xbf62bef13f62bef1
.quad 0x3f8000003f80,0x3f8000003f80,0xbf62bef13f62bef1,0xbe95bf753e95bf75,0x3f55bf0ebf55bf0e,0x3f0e3f55bf0e3f55,0x3dc93f7fbdc93f7f,0xbf46bf223f46bf22
.quad 0xbf6dbec43f6dbec4,0x3f6d3ec4bf6d3ec4,0x3f46bf22bf46bf22,0xbf7fbdc93f7fbdc9,0x3e483f7bbe483f7b,0x3f7bbe48bf7bbe48,0xbf75be953f75be95,0xbf623ef13f623ef1
.quad 0x3f35bf35bf35bf35,0x3f35bf35bf35bf35,0x3e953f75be953f75,0xbef13f623ef13f62,0xbf7bbe483f7bbe48,0x3e48bf7bbe48bf7b,0x3f22bf46bf22bf46,0x3dc93f7fbdc93f7f
.quad 0x3ec43f6dbec43f6d,0xbec4bf6d3ec4bf6d,0xbf7fbdc93f7fbdc9,0x3f223f46bf223f46,0x3f0ebf55bf0ebf55,0xbf55bf0e3f55bf0e,0x3ef13f62bef13f62,0x3f753e95bf753e95
.quad 0x3f8000003f80,0x3f8000003f80,0xbf46bf223f46bf22,0xbdc9bf7f3dc9bf7f,0x3f7bbe48bf7bbe48,0x3e483f7bbe483f7b,0xbef13f623ef13f62,0xbe95bf753e95bf75
.quad 0xbec4bf6d3ec4bf6d,0x3ec43f6dbec43f6d,0x3f753e95bf753e95,0xbef1bf623ef1bf62,0xbf553f0e3f553f0e,0x3f0e3f55bf0e3f55,0x3dc9bf7fbdc9bf7f,0xbf22bf463f22bf46
.quad 0x3f353f35bf353f35,0x3f353f35bf353f35,0xbf7f3dc93f7f3dc9,0xbf46bf223f46bf22,0x3f0ebf55bf0ebf55,0x3f553f0ebf553f0e,0x3e953f75be953f75,0xbf62bef13f62bef1
.quad 0xbf6dbec43f6dbec4,0x3f6d3ec4bf6d3ec4,0x3f62bef1bf62bef1,0xbf75be953f75be95,0xbe483f7b3e483f7b,0x3f7b3e48bf7b3e48,0xbf22bf463f22bf46,0xbf7fbdc93f7fbdc9
.quad 0x3f800000bf003f00,0x3ec4bf6d3ec43f6d,0xbf800000bf003f00,0x3f6dbec43f6d3ec4,0x3f800000bf003f00,0x3f6d3ec43f6dbec4,0xbf800000bf003f00,0x3ec43f6d3ec4bf6d
.quad 0x3f800000bf003f00,0xbec43f6dbec4bf6d,0xbf800000bf003f00,0xbf6d3ec4bf6dbec4,0x3f800000bf003f00,0xbf6dbec4bf6d3ec4,0xbf800000bf003f00,0xbec4bf6dbec43f6d
.quad 0x3f800000bf003f00,0x3ec4bf6d3ec43f6d,0xbf800000bf003f00,0x3f6dbec43f6d3ec4,0x3f800000bf003f00,0x3f6d3ec43f6dbec4,0xbf800000bf003f00,0x3ec43f6d3ec4bf6d
.quad 0x3f800000bf003f00,0xbec43f6dbec4bf6d,0xbf800000bf003f00,0xbf6d3ec4bf6dbec4,0x3f800000bf003f00,0xbf6dbec4bf6d3ec4,0xbf800000bf003f00,0xbec4bf6dbec43f6d
.quad 0x3dc9bf7f3dc93f7f,0x3ef1bf623ef13f62,0x3e95bf753e953f75,0x3f7fbdc93f7f3dc9,0x3ef1bf623ef13f62,0x3f223f463f22bf46,0x3f22bf463f223f46,0xbe953f75be95bf75
.quad 0x3f46bf223f463f22,0xbf753e95bf75be95,0x3f62bef13f623ef1,0xbf46bf22bf463f22,0x3f75be953f753e95,0x3dc9bf7f3dc93f7f,0x3f7fbdc93f7f3dc9,0x3f62bef13f623ef1
.quad 0x3f7f3dc93f7fbdc9,0x3f623ef13f62bef1,0x3f753e953f75be95,0x3dc93f7f3dc9bf7f,0x3f623ef13f62bef1,0xbf463f22bf46bf22,0x3f463f223f46bf22,0xbf75be95bf753e95
.quad 0x3f223f463f22bf46,0xbe95bf75be953f75,0x3ef13f623ef1bf62,0x3f22bf463f223f46,0x3e953f753e95bf75,0x3f7f3dc93f7fbdc9,0x3dc93f7f3dc9bf7f,0x3ef13f623ef1bf62
.quad 0x3e48bf7b3e483f7b,0x3f0ebf553f0e3f55,0x3f0ebf553f0e3f55,0x3f7b3e483f7bbe48,0x3f55bf0e3f553f0e,0x3e483f7b3e48bf7b,0x3f7bbe483f7b3e48,0xbf553f0ebf55bf0e
.quad 0x3f7b3e483f7bbe48,0xbf55bf0ebf553f0e,0x3f553f0e3f55bf0e,0x3e48bf7b3e483f7b,0x3f0e3f553f0ebf55,0x3f7bbe483f7b3e48,0x3e483f7b3e48bf7b,0x3f0e3f553f0ebf55
.quad 0xbe483f7bbe48bf7b,0xbf0e3f55bf0ebf55,0xbf0e3f55bf0ebf55,0xbf7bbe48bf7b3e48,0xbf553f0ebf55bf0e,0xbe48bf7bbe483f7b,0xbf7b3e48bf7bbe48,0x3f55bf0e3f553f0e
.quad 0xbf7bbe48bf7b3e48,0x3f553f0e3f55bf0e,0xbf55bf0ebf553f0e,0xbe483f7bbe48bf7b,0xbf0ebf55bf0e3f55,0xbf7b3e48bf7bbe48,0xbe48bf7bbe483f7b,0xbf0ebf55bf0e3f55
.quad 0x3e95bf753e953f75,0x3f22bf463f223f46,0x3f46bf223f463f22,0x3f623ef13f62bef1,0x3f7fbdc93f7f3dc9,0xbe953f75be95bf75,0x3f623ef13f62bef1,0xbf7fbdc9bf7f3dc9
.quad 0x3ef13f623ef1bf62,0xbdc9bf7fbdc93f7f,0xbdc93f7fbdc9bf7f,0x3f75be953f753e95,0xbf223f46bf22bf46,0x3ef13f623ef1bf62,0xbf753e95bf75be95,0xbf463f22bf46bf22
.quad 0xbf75be95bf753e95,0xbf46bf22bf463f22,0xbf22bf46bf223f46,0x3ef1bf623ef13f62,0xbdc9bf7fbdc93f7f,0x3f753e953f75be95,0x3ef1bf623ef13f62,0xbdc93f7fbdc9bf7f
.quad 0x3f62bef13f623ef1,0xbf7f3dc9bf7fbdc9,0x3f7f3dc93f7fbdc9,0xbe95bf75be953f75,0x3f463f223f46bf22,0x3f62bef13f623ef1,0x3e953f753e95bf75,0x3f223f463f22bf46
.quad 0x3f35bf353f353f35,0x3f6dbec43f6d3ec4,0x3f353f353f35bf35,0xbec43f6dbec4bf6d,0xbf353f35bf35bf35,0xbec4bf6dbec43f6d,0xbf35bf35bf353f35,0x3f6d3ec43f6dbec4
.quad 0x3f35bf353f353f35,0xbf6d3ec4bf6dbec4,0x3f353f353f35bf35,0x3ec4bf6d3ec43f6d,0xbf353f35bf35bf35,0x3ec43f6d3ec4bf6d,0xbf35bf35bf353f35,0xbf6dbec4bf6d3ec4
.quad 0x3f35bf353f353f35,0x3f6dbec43f6d3ec4,0x3f353f353f35bf35,0xbec43f6dbec4bf6d,0xbf353f35bf35bf35,0xbec4bf6dbec43f6d,0xbf35bf35bf353f35,0x3f6d3ec43f6dbec4
.quad 0x3f35bf353f353f35,0xbf6d3ec4bf6dbec4,0x3f353f353f35bf35,0x3ec4bf6d3ec43f6d,0xbf353f35bf35bf35,0x3ec43f6d3ec4bf6d,0xbf35bf35bf353f35,0xbf6dbec4bf6d3ec4
.quad 0x3f46bf223f463f22,0x3f75be953f753e95,0x3ef13f623ef1bf62,0xbf223f46bf22bf46,0xbf753e95bf75be95,0x3dc9bf7f3dc93f7f,0xbdc9bf7fbdc93f7f,0x3ef13f623ef1bf62
.quad 0x3f7f3dc93f7fbdc9,0xbf62bef1bf623ef1,0xbe953f75be95bf75,0x3f7fbdc93f7f3dc9,0xbf62bef1bf623ef1,0xbf463f22bf46bf22,0x3f22bf463f223f46,0x3e95bf753e953f75
.quad 0x3f223f463f22bf46,0x3e953f753e95bf75,0xbf623ef1bf62bef1,0xbf46bf22bf463f22,0xbe95bf75be953f75,0x3f7f3dc93f7fbdc9,0x3f7fbdc93f7f3dc9,0xbf623ef1bf62bef1
.quad 0xbdc93f7fbdc9bf7f,0x3ef1bf623ef13f62,0xbf75be95bf753e95,0x3dc93f7f3dc9bf7f,0x3ef1bf623ef13f62,0xbf22bf46bf223f46,0x3f463f223f46bf22,0x3f753e953f75be95
.quad 0x3f55bf0e3f553f0e,0x3f7bbe483f7b3e48,0x3e483f7b3e48bf7b,0xbf553f0ebf55bf0e,0xbf7bbe48bf7b3e48,0x3f0ebf553f0e3f55,0x3f0ebf553f0e3f55,0xbe483f7bbe48bf7b
.quad 0x3f0e3f553f0ebf55,0xbe48bf7bbe483f7b,0xbf7b3e48bf7bbe48,0x3f0e3f553f0ebf55,0x3e48bf7b3e483f7b,0xbf55bf0ebf553f0e,0x3f553f0e3f55bf0e,0x3f7b3e483f7bbe48
.quad 0xbf553f0ebf55bf0e,0xbf7b3e48bf7bbe48,0xbe48bf7bbe483f7b,0x3f55bf0e3f553f0e,0x3f7b3e483f7bbe48,0xbf0e3f55bf0ebf55,0xbf0e3f55bf0ebf55,0x3e48bf7b3e483f7b
.quad 0xbf0ebf55bf0e3f55,0x3e483f7b3e48bf7b,0x3f7bbe483f7b3e48,0xbf0ebf55bf0e3f55,0xbe483f7bbe48bf7b,0x3f553f0e3f55bf0e,0xbf55bf0ebf553f0e,0xbf7bbe48bf7b3e48
.quad 0x3f62bef13f623ef1,0x3f7fbdc93f7f3dc9,0xbdc93f7fbdc9bf7f,0xbf753e95bf75be95,0xbf46bf22bf463f22,0x3f62bef13f623ef1,0x3f75be953f753e95,0xbf463f22bf46bf22
.quad 0xbe953f75be95bf75,0x3f22bf463f223f46,0xbf22bf46bf223f46,0xbef13f62bef1bf62,0x3f7fbdc93f7f3dc9,0x3e95bf753e953f75,0xbef13f62bef1bf62,0xbdc93f7fbdc9bf7f
.quad 0xbef1bf62bef13f62,0xbdc9bf7fbdc93f7f,0x3f7f3dc93f7fbdc9,0x3e953f753e95bf75,0xbf223f46bf22bf46,0xbef1bf62bef13f62,0xbe95bf75be953f75,0x3f223f463f22bf46
.quad 0x3f753e953f75be95,0xbf46bf22bf463f22,0xbf463f22bf46bf22,0x3f623ef13f62bef1,0xbdc9bf7fbdc93f7f,0xbf75be95bf753e95,0x3f623ef13f62bef1,0x3f7f3dc93f7fbdc9
.quad 0x3d49bf803d493f80,0x3edbbf673edb3f67,0x3e16bf7d3e163f7d,0x3f78be793f783e79,0x3e79bf783e793f78,0x3f4e3f183f4ebf18,0x3eacbf713eac3f71,0x3d493f803d49bf80
.quad 0x3edbbf673edb3f67,0xbf3e3f2cbf3ebf2c,0x3f04bf5c3f043f5c,0xbf7dbe16bf7d3e16,0x3f18bf4e3f183f4e,0xbf04bf5cbf043f5c,0x3f2cbf3e3f2c3f3e,0x3eacbf713eac3f71
.quad 0x3f3ebf2c3f3e3f2c,0x3f71beac3f713eac,0x3f4ebf183f4e3f18,0x3f5c3f043f5cbf04,0x3f5cbf043f5c3f04,0x3e163f7d3e16bf7d,0x3f67bedb3f673edb,0xbf2c3f3ebf2cbf3e
.quad 0x3f71beac3f713eac,0xbf80bd49bf803d49,0x3f78be793f783e79,0xbf18bf4ebf183f4e,0x3f7dbe163f7d3e16,0x3e79bf783e793f78,0x3f80bd493f803d49,0x3f67bedb3f673edb
.quad 0x3e16bf7d3e163f7d,0x3f04bf5c3f043f5c,0x3edbbf673edb3f67,0x3f803d493f80bd49,0x3f2cbf3e3f2c3f3e,0x3edb3f673edbbf67,0x3f5cbf043f5c3f04,0xbf183f4ebf18bf4e
.quad 0x3f78be793f783e79,0xbf7dbe16bf7d3e16,0x3f803d493f80bd49,0xbeacbf71beac3f71,0x3f713eac3f71beac,0x3f2cbf3e3f2c3f3e,0x3f4e3f183f4ebf18,0x3f783e793f78be79
.quad 0x3f183f4e3f18bf4e,0x3e793f783e79bf78,0x3eac3f713eacbf71,0xbf3e3f2cbf3ebf2c,0x3d493f803d49bf80,0xbf71beacbf713eac,0xbe793f78be79bf78,0xbe16bf7dbe163f7d
.quad 0xbf043f5cbf04bf5c,0x3f4ebf183f4e3f18,0xbf3e3f2cbf3ebf2c,0x3f673edb3f67bedb,0xbf673edbbf67bedb,0x3d493f803d49bf80,0xbf7d3e16bf7dbe16,0xbf5c3f04bf5cbf04
.quad 0x3e79bf783e793f78,0x3f18bf4e3f183f4e,0x3f2cbf3e3f2c3f3e,0x3f713eac3f71beac,0x3f71beac3f713eac,0xbd493f80bd49bf80,0x3f7d3e163f7dbe16,0xbf783e79bf78be79
.quad 0x3f4e3f183f4ebf18,0xbf04bf5cbf043f5c,0x3edb3f673edbbf67,0x3f2cbf3e3f2c3f3e,0xbd493f80bd49bf80,0x3f673edb3f67bedb,0xbf043f5cbf04bf5c,0xbe163f7dbe16bf7d
.quad 0xbf5c3f04bf5cbf04,0xbf7d3e16bf7dbe16,0xbf803d49bf80bd49,0xbedbbf67bedb3f67,0xbf67bedbbf673edb,0x3f3ebf2c3f3e3f2c,0xbf18bf4ebf183f4e,0x3f5c3f043f5cbf04
.quad 0xbe16bf7dbe163f7d,0xbe793f78be79bf78,0x3eacbf713eac3f71,0xbf803d49bf80bd49,0x3f3ebf2c3f3e3f2c,0xbeacbf71beac3f71,0x3f78be793f783e79,0x3f4ebf183f4e3f18
.quad 0x3eacbf713eac3f71,0x3f2cbf3e3f2c3f3e,0x3f5cbf043f5c3f04,0x3f4e3f183f4ebf18,0x3f7d3e163f7dbe16,0xbf043f5cbf04bf5c,0x3f2c3f3e3f2cbf3e,0xbf67bedbbf673edb
.quad 0x3d493f803d49bf80,0x3eacbf713eac3f71,0xbf183f4ebf18bf4e,0x3f783e793f78be79,0xbf783e79bf78be79,0xbe163f7dbe16bf7d,0xbf67bedbbf673edb,0xbf80bd49bf803d49
.quad 0xbedbbf67bedb3f67,0xbd49bf80bd493f80,0x3e79bf783e793f78,0x3f7dbe163f7d3e16,0x3f4ebf183f4e3f18,0x3e793f783e79bf78,0x3f803d493f80bd49,0xbf713eacbf71beac
.quad 0x3f3e3f2c3f3ebf2c,0xbedbbf67bedb3f67,0x3e163f7d3e16bf7d,0x3f5cbf043f5c3f04,0xbf043f5cbf04bf5c,0x3f183f4e3f18bf4e,0xbf713eacbf71beac,0xbf3e3f2cbf3ebf2c
.quad 0x3f3ebf2c3f3e3f2c,0x3f71beac3f713eac,0x3f183f4e3f18bf4e,0xbf043f5cbf04bf5c,0xbf5c3f04bf5cbf04,0xbe16bf7dbe163f7d,0xbedbbf67bedb3f67,0x3f3e3f2c3f3ebf2c
.quad 0x3f71beac3f713eac,0xbf80bd49bf803d49,0x3e793f783e79bf78,0x3f4ebf183f4e3f18,0xbf7d3e16bf7dbe16,0xbe793f78be79bf78,0xbd49bf80bd493f80,0xbedbbf67bedb3f67
.quad 0x3f803d493f80bd49,0x3f673edb3f67bedb,0xbe163f7dbe16bf7d,0xbf783e79bf78be79,0xbf78be79bf783e79,0x3f18bf4e3f183f4e,0x3eacbf713eac3f71,0x3d493f803d49bf80
.quad 0x3f673edb3f67bedb,0xbf2cbf3ebf2c3f3e,0xbf043f5cbf04bf5c,0x3f7d3e163f7dbe16,0xbf4ebf18bf4e3f18,0xbf5c3f04bf5cbf04,0x3f2cbf3e3f2c3f3e,0x3eacbf713eac3f71
.quad 0x3f4ebf183f4e3f18,0x3f78be793f783e79,0x3eac3f713eacbf71,0xbf3e3f2cbf3ebf2c,0xbf803d49bf80bd49,0x3eacbf713eac3f71,0x3e79bf783e793f78,0x3e163f7d3e16bf7d
.quad 0x3f5c3f043f5cbf04,0xbf18bf4ebf183f4e,0xbf3e3f2cbf3ebf2c,0x3f673edb3f67bedb,0xbedbbf67bedb3f67,0xbf803d49bf80bd49,0x3f7dbe163f7d3e16,0x3f5cbf043f5c3f04
.quad 0xbe163f7dbe16bf7d,0xbf043f5cbf04bf5c,0xbf67bedbbf673edb,0x3d49bf803d493f80,0x3f2cbf3e3f2c3f3e,0x3edb3f673edbbf67,0x3f043f5c3f04bf5c,0xbf4ebf18bf4e3f18
.quad 0xbf783e79bf78be79,0x3f7d3e163f7dbe16,0x3d49bf803d493f80,0xbf713eacbf71beac,0x3f713eac3f71beac,0x3f2cbf3e3f2c3f3e,0xbf183f4ebf18bf4e,0xbe793f78be79bf78
.quad 0x3f5cbf043f5c3f04,0x3f7dbe163f7d3e16,0x3d493f803d49bf80,0xbf673edbbf67bedb,0xbf67bedbbf673edb,0x3f3ebf2c3f3e3f2c,0x3f4ebf183f4e3f18,0xbf043f5cbf04bf5c
.quad 0x3e163f7d3e16bf7d,0x3e79bf783e793f78,0xbf71beacbf713eac,0x3d493f803d49bf80,0x3f3ebf2c3f3e3f2c,0xbeacbf71beac3f71,0x3e793f783e79bf78,0x3f183f4e3f18bf4e
.quad 0xbf78be79bf783e79,0xbf4ebf18bf4e3f18,0x3f2cbf3e3f2c3f3e,0x3f713eac3f71beac,0x3eac3f713eacbf71,0xbf80bd49bf803d49,0xbf7dbe16bf7d3e16,0x3f78be793f783e79
.quad 0x3f18bf4e3f183f4e,0xbf5c3f04bf5cbf04,0x3edb3f673edbbf67,0x3f2cbf3e3f2c3f3e,0xbf80bd49bf803d49,0xbedb3f67bedbbf67,0x3f04bf5c3f043f5c,0x3e16bf7d3e163f7d
.quad 0x3f67bedb3f673edb,0x3f80bd493f803d49,0xbe793f78be79bf78,0xbf7d3e16bf7dbe16,0xbf18bf4ebf183f4e,0x3f78be793f783e79,0x3f803d493f80bd49,0xbf713eacbf71beac
.quad 0xbf2c3f3ebf2cbf3e,0x3f67bedb3f673edb,0xbe16bf7dbe163f7d,0xbf5c3f04bf5cbf04,0x3f5c3f043f5cbf04,0x3f4ebf183f4e3f18,0xbf713eacbf71beac,0xbf3e3f2cbf3ebf2c
.quad 0x3eacbf713eac3f71,0x3f2cbf3e3f2c3f3e,0x3f043f5c3f04bf5c,0xbf183f4ebf18bf4e,0xbf7dbe16bf7d3e16,0x3f04bf5c3f043f5c,0x3f3ebf2c3f3e3f2c,0xbedb3f67bedbbf67
.quad 0x3d493f803d49bf80,0x3eacbf713eac3f71,0xbf4ebf18bf4e3f18,0xbe793f78be79bf78,0x3f78be793f783e79,0x3e16bf7d3e163f7d,0xbedb3f67bedbbf67,0xbd493f80bd49bf80
.quad 0x3f803f003f00,0x3f8000003f80,0xbf803f003f00,0xbf353f353f353f35,0x3f803f003f00,0xbf8000003f800000,0xbf803f003f00,0xbf35bf353f35bf35
.quad 0x3f803f003f00,0xbf800000bf80,0xbf803f003f00,0x3f35bf35bf35bf35,0x3f803f003f00,0x3f800000bf800000,0xbf803f003f00,0x3f353f35bf353f35
.quad 0x3f803f003f00,0x3f8000003f80,0xbf803f003f00,0xbf353f353f353f35,0x3f803f003f00,0xbf8000003f800000,0xbf803f003f00,0xbf35bf353f35bf35
.quad 0x3f803f003f00,0xbf800000bf80,0xbf803f003f00,0x3f35bf35bf35bf35,0x3f803f003f00,0x3f800000bf800000,0xbf803f003f00,0x3f353f35bf353f35
.quad 0xbf800000bf80,0xbf800000bf80,0x3e48bf7bbe48bf7b,0x3f55bf0ebf55bf0e,0x3ec4bf6dbec4bf6d,0x3f6d3ec4bf6d3ec4,0x3f0ebf55bf0ebf55,0x3e483f7bbe483f7b
.quad 0x3f35bf35bf35bf35,0xbf353f353f353f35,0x3f55bf0ebf55bf0e,0xbf7bbe483f7bbe48,0x3f6dbec4bf6dbec4,0xbec4bf6d3ec4bf6d,0x3f7bbe48bf7bbe48,0x3f0ebf55bf0ebf55
.quad 0x3f800000bf800000,0x3f800000bf800000,0x3f7b3e48bf7b3e48,0x3f0e3f55bf0e3f55,0x3f6d3ec4bf6d3ec4,0xbec43f6d3ec43f6d,0x3f553f0ebf553f0e,0xbf7b3e483f7b3e48
.quad 0x3f353f35bf353f35,0xbf35bf353f35bf35,0x3f0e3f55bf0e3f55,0x3e48bf7bbe48bf7b,0x3ec43f6dbec43f6d,0x3f6dbec4bf6dbec4,0x3e483f7bbe483f7b,0x3f553f0ebf553f0e
.quad 0x3f8000003f80,0x3f8000003f80,0xbec43f6d3ec43f6d,0xbf6d3ec43f6d3ec4,0xbf353f353f353f35,0xbf35bf353f35bf35,0xbf6d3ec43f6d3ec4,0x3ec4bf6dbec4bf6d
.quad 0xbf8000003f800000,0x3f800000bf800000,0xbf6dbec43f6dbec4,0x3ec43f6dbec43f6d,0xbf35bf353f35bf35,0xbf353f353f353f35,0xbec4bf6d3ec4bf6d,0xbf6dbec43f6dbec4
.quad 0xbf800000bf80,0xbf800000bf80,0x3ec4bf6dbec4bf6d,0x3f6dbec4bf6dbec4,0x3f35bf35bf35bf35,0x3f353f35bf353f35,0x3f6dbec4bf6dbec4,0xbec43f6d3ec43f6d
.quad 0x3f800000bf800000,0xbf8000003f800000,0x3f6d3ec4bf6d3ec4,0xbec4bf6d3ec4bf6d,0x3f353f35bf353f35,0x3f35bf35bf35bf35,0x3ec43f6dbec43f6d,0x3f6d3ec4bf6d3ec4
.quad 0xbf800000bf80,0xbf800000bf80,0x3f0ebf55bf0ebf55,0x3f7bbe48bf7bbe48,0x3f6dbec4bf6dbec4,0x3ec43f6dbec43f6d,0x3f7b3e48bf7b3e48,0xbf553f0e3f553f0e
.quad 0x3f353f35bf353f35,0xbf35bf353f35bf35,0x3e483f7bbe483f7b,0x3f0ebf55bf0ebf55,0xbec43f6d3ec43f6d,0x3f6d3ec4bf6d3ec4,0xbf553f0e3f553f0e,0xbe483f7b3e483f7b
.quad 0xbf8000003f800000,0xbf8000003f800000,0xbf55bf0e3f55bf0e,0xbe48bf7b3e48bf7b,0xbec4bf6d3ec4bf6d,0x3f6dbec4bf6dbec4,0x3e48bf7bbe48bf7b,0x3f0e3f55bf0e3f55
.quad 0x3f35bf35bf35bf35,0xbf353f353f353f35,0x3f7bbe48bf7bbe48,0xbf55bf0e3f55bf0e,0x3f6d3ec4bf6d3ec4,0x3ec4bf6dbec4bf6d,0x3f0e3f55bf0e3f55,0x3f7b3e48bf7b3e48
.quad 0x3f8000003f80,0x3f8000003f80,0xbf8000003f800000,0xbf35bf353f35bf35,0xbf800000bf80,0x3f800000bf800000,0x3f800000bf800000,0xbf353f353f353f35
.quad 0x3f8000003f80,0xbf800000bf80,0xbf8000003f800000,0x3f353f35bf353f35,0xbf800000bf80,0xbf8000003f800000,0x3f800000bf800000,0x3f35bf35bf35bf35
.quad 0x3f8000003f80,0x3f8000003f80,0xbf8000003f800000,0xbf35bf353f35bf35,0xbf800000bf80,0x3f800000bf800000,0x3f800000bf800000,0xbf353f353f353f35
.quad 0x3f8000003f80,0xbf800000bf80,0xbf8000003f800000,0x3f353f35bf353f35,0xbf800000bf80,0xbf8000003f800000,0x3f800000bf800000,0x3f35bf35bf35bf35
.quad 0xbf800000bf80,0xbf800000bf80,0x3f7b3e48bf7b3e48,0x3f0e3f55bf0e3f55,0xbec43f6d3ec43f6d,0xbf6dbec43f6dbec4,0xbf55bf0e3f55bf0e,0x3f7bbe48bf7bbe48
.quad 0x3f35bf35bf35bf35,0xbf353f353f353f35,0x3f0e3f55bf0e3f55,0x3e48bf7bbe48bf7b,0xbf6d3ec43f6d3ec4,0x3ec43f6dbec43f6d,0xbe48bf7b3e48bf7b,0xbf55bf0e3f55bf0e
.quad 0x3f800000bf800000,0x3f800000bf800000,0xbe483f7b3e483f7b,0xbf553f0e3f553f0e,0xbf6dbec43f6dbec4,0x3ec4bf6dbec4bf6d,0x3f0ebf55bf0ebf55,0x3e483f7bbe483f7b
.quad 0x3f353f35bf353f35,0xbf35bf353f35bf35,0xbf553f0e3f553f0e,0x3f7b3e48bf7b3e48,0xbec4bf6d3ec4bf6d,0xbf6d3ec43f6d3ec4,0x3f7bbe48bf7bbe48,0x3f0ebf55bf0ebf55
.quad 0x3f8000003f80,0x3f8000003f80,0xbf6dbec43f6dbec4,0xbec4bf6d3ec4bf6d,0x3f35bf35bf35bf35,0x3f353f35bf353f35,0x3ec43f6dbec43f6d,0xbf6dbec43f6dbec4
.quad 0xbf8000003f800000,0x3f800000bf800000,0x3ec4bf6dbec4bf6d,0xbf6d3ec43f6d3ec4,0x3f353f35bf353f35,0x3f35bf35bf35bf35,0xbf6d3ec43f6d3ec4,0xbec43f6d3ec43f6d
.quad 0xbf800000bf80,0xbf800000bf80,0x3f6d3ec4bf6d3ec4,0x3ec43f6dbec43f6d,0xbf353f353f353f35,0xbf35bf353f35bf35,0xbec4bf6d3ec4bf6d,0x3f6d3ec4bf6d3ec4
.quad 0x3f800000bf800000,0xbf8000003f800000,0xbec43f6d3ec43f6d,0x3f6dbec4bf6dbec4,0xbf35bf353f35bf35,0xbf353f353f353f35,0x3f6dbec4bf6dbec4,0x3ec4bf6dbec4bf6d
.quad 0xbf800000bf80,0xbf800000bf80,0x3f553f0ebf553f0e,0x3e483f7bbe483f7b,0xbf6d3ec43f6d3ec4,0xbec4bf6d3ec4bf6d,0x3e48bf7bbe48bf7b,0x3f0e3f55bf0e3f55
.quad 0x3f353f35bf353f35,0xbf35bf353f35bf35,0xbf7b3e483f7b3e48,0x3f553f0ebf553f0e,0x3ec4bf6dbec4bf6d,0xbf6dbec43f6dbec4,0x3f0e3f55bf0e3f55,0x3f7b3e48bf7b3e48
.quad 0xbf8000003f800000,0xbf8000003f800000,0x3f0ebf55bf0ebf55,0x3f7bbe48bf7bbe48,0x3ec43f6dbec43f6d,0xbf6d3ec43f6d3ec4,0xbf7bbe483f7bbe48,0x3f55bf0ebf55bf0e
.quad 0x3f35bf35bf35bf35,0xbf353f353f353f35,0x3e483f7bbe483f7b,0x3f0ebf55bf0ebf55,0xbf6dbec43f6dbec4,0xbec43f6d3ec43f6d,0x3f55bf0ebf55bf0e,0x3e48bf7bbe48bf7b
.quad 0xbf8000003f800000,0xbf8000003f800000,0xbf7fbdc93f7fbdc9,0xbf22bf463f22bf46,0xbf7bbe483f7bbe48,0x3e48bf7bbe48bf7b,0xbf75be953f75be95,0x3f62bef1bf62bef1
.quad 0xbf6dbec43f6dbec4,0x3f6d3ec4bf6d3ec4,0xbf62bef13f62bef1,0x3e953f75be953f75,0xbf55bf0e3f55bf0e,0xbf0e3f553f0e3f55,0xbf46bf223f46bf22,0xbf7f3dc93f7f3dc9
.quad 0xbf35bf353f35bf35,0xbf35bf353f35bf35,0xbf22bf463f22bf46,0x3dc9bf7fbdc9bf7f,0xbf0ebf553f0ebf55,0x3f55bf0ebf55bf0e,0xbef1bf623ef1bf62,0x3f753e95bf753e95
.quad 0xbec4bf6d3ec4bf6d,0x3ec43f6dbec43f6d,0xbe95bf753e95bf75,0xbef13f623ef13f62,0xbe48bf7b3e48bf7b,0xbf7b3e483f7b3e48,0xbdc9bf7f3dc9bf7f,0xbf46bf223f46bf22
.quad 0x3f800000bf800000,0x3f800000bf800000,0x3f753e95bf753e95,0x3ef13f62bef13f62,0x3f553f0ebf553f0e,0xbf0e3f553f0e3f55,0x3f223f46bf223f46,0xbf7fbdc93f7fbdc9
.quad 0x3ec43f6dbec43f6d,0xbec4bf6d3ec4bf6d,0x3dc93f7fbdc93f7f,0x3f22bf46bf22bf46,0xbe483f7b3e483f7b,0x3f7b3e48bf7b3e48,0xbef13f623ef13f62,0x3e953f75be953f75
.quad 0xbf353f353f353f35,0xbf353f353f353f35,0xbf623ef13f623ef1,0xbf75be953f75be95,0xbf7b3e483f7b3e48,0xbe48bf7b3e48bf7b,0xbf7fbdc93f7fbdc9,0x3f46bf22bf46bf22
.quad 0xbf6dbec43f6dbec4,0x3f6d3ec4bf6d3ec4,0xbf46bf223f46bf22,0x3dc93f7fbdc93f7f,0xbf0ebf553f0ebf55,0xbf553f0e3f553f0e,0xbe95bf753e95bf75,0xbf62bef13f62bef1
.quad 0xbf8000003f800000,0xbf8000003f800000,0xbf62bef13f62bef1,0xbe95bf753e95bf75,0xbf0ebf553f0ebf55,0x3f55bf0ebf55bf0e,0xbdc9bf7f3dc9bf7f,0x3f463f22bf463f22
.quad 0x3ec4bf6dbec4bf6d,0xbec43f6d3ec43f6d,0x3f46bf22bf46bf22,0xbf7fbdc93f7fbdc9,0x3f7bbe48bf7bbe48,0xbe48bf7b3e48bf7b,0x3f753e95bf753e95,0x3f62bef1bf62bef1
.quad 0x3f353f35bf353f35,0x3f353f35bf353f35,0x3e953f75be953f75,0xbef13f623ef13f62,0xbe483f7b3e483f7b,0xbf7bbe483f7bbe48,0xbf223f463f223f46,0xbdc9bf7f3dc9bf7f
.quad 0xbf6d3ec43f6d3ec4,0x3f6dbec4bf6dbec4,0xbf7fbdc93f7fbdc9,0x3f223f46bf223f46,0xbf55bf0e3f55bf0e,0xbf0e3f553f0e3f55,0xbef1bf623ef1bf62,0xbf75be953f75be95
.quad 0x3f800000bf800000,0x3f800000bf800000,0x3f463f22bf463f22,0x3dc93f7fbdc93f7f,0x3e483f7bbe483f7b,0xbf7b3e483f7b3e48,0xbef13f623ef13f62,0xbe95bf753e95bf75
.quad 0xbf6d3ec43f6d3ec4,0x3f6dbec4bf6dbec4,0xbf75be953f75be95,0x3ef13f62bef13f62,0xbf0ebf553f0ebf55,0xbf553f0e3f553f0e,0x3dc9bf7fbdc9bf7f,0xbf22bf463f22bf46
.quad 0x3f35bf35bf35bf35,0x3f35bf35bf35bf35,0x3f7fbdc9bf7fbdc9,0x3f463f22bf463f22,0x3f553f0ebf553f0e,0xbf0e3f553f0e3f55,0x3e953f75be953f75,0xbf62bef13f62bef1
.quad 0xbec43f6d3ec43f6d,0x3ec4bf6dbec4bf6d,0xbf623ef13f623ef1,0x3f753e95bf753e95,0xbf7bbe483f7bbe48,0xbe483f7b3e483f7b,0xbf22bf463f22bf46,0xbf7fbdc93f7fbdc9
.quad 0xbf8000003f800000,0xbf8000003f800000,0x3dc9bf7fbdc9bf7f,0x3f46bf22bf46bf22,0x3f7b3e48bf7b3e48,0xbe483f7b3e483f7b,0xbe953f753e953f75,0xbef1bf623ef1bf62
.quad 0xbf6dbec43f6dbec4,0x3f6d3ec4bf6d3ec4,0x3ef1bf62bef1bf62,0xbf753e953f753e95,0x3f553f0ebf553f0e,0x3f0ebf55bf0ebf55,0xbf223f463f223f46,0x3dc93f7fbdc93f7f
.quad 0xbf35bf353f35bf35,0xbf35bf353f35bf35,0x3f46bf22bf46bf22,0x3f7f3dc9bf7f3dc9,0x3f0e3f55bf0e3f55,0xbf553f0e3f553f0e,0xbf623ef13f623ef1,0x3e95bf75be95bf75
.quad 0xbec4bf6d3ec4bf6d,0x3ec43f6dbec43f6d,0x3f75be95bf75be95,0xbf62bef13f62bef1,0x3e483f7bbe483f7b,0x3f7bbe48bf7bbe48,0xbf7f3dc93f7f3dc9,0xbf223f463f223f46
.quad 0x3f800000bf800000,0x3f800000bf800000,0xbe953f753e953f75,0xbf623ef13f623ef1,0xbf55bf0e3f55bf0e,0x3f0ebf55bf0ebf55,0x3f46bf22bf46bf22,0xbdc93f7f3dc93f7f
.quad 0x3ec43f6dbec43f6d,0xbec4bf6d3ec4bf6d,0xbf7f3dc93f7f3dc9,0x3f463f22bf463f22,0x3e48bf7bbe48bf7b,0xbf7bbe483f7bbe48,0x3f623ef1bf623ef1,0x3f75be95bf75be95
.quad 0xbf353f353f353f35,0xbf353f353f353f35,0xbef1bf623ef1bf62,0x3e95bf75be95bf75,0x3f7bbe48bf7bbe48,0x3e483f7bbe483f7b,0xbdc93f7f3dc93f7f,0xbf22bf463f22bf46
.quad 0xbf6dbec43f6dbec4,0x3f6d3ec4bf6d3ec4,0x3f22bf46bf22bf46,0xbf7f3dc93f7f3dc9,0x3f0e3f55bf0e3f55,0x3f55bf0ebf55bf0e,0xbf753e953f753e95,0xbef13f623ef13f62
.quad 0xbf8000003f800000,0xbf8000003f800000,0x3ef1bf62bef1bf62,0x3f75be95bf75be95,0x3f0e3f55bf0e3f55,0xbf553f0e3f553f0e,0xbf7f3dc93f7f3dc9,0x3f22bf46bf22bf46
.quad 0x3ec4bf6dbec4bf6d,0xbec43f6d3ec43f6d,0x3f223f46bf223f46,0x3dc9bf7fbdc9bf7f,0xbf7b3e483f7b3e48,0x3e483f7bbe483f7b,0x3e95bf75be95bf75,0xbef1bf623ef1bf62
.quad 0x3f353f35bf353f35,0x3f353f35bf353f35,0xbf753e953f753e95,0xbf62bef13f62bef1,0x3e48bf7bbe48bf7b,0x3f7b3e48bf7b3e48,0x3f463f22bf463f22,0xbf7f3dc93f7f3dc9
.quad 0xbf6d3ec43f6d3ec4,0x3f6dbec4bf6dbec4,0x3dc9bf7fbdc9bf7f,0xbf463f223f463f22,0x3f553f0ebf553f0e,0x3f0ebf55bf0ebf55,0xbf623ef13f623ef1,0xbe953f753e953f75
.quad 0x3f800000bf800000,0x3f800000bf800000,0xbf223f463f223f46,0xbf7f3dc93f7f3dc9,0xbe48bf7b3e48bf7b,0x3f7bbe48bf7bbe48,0x3f623ef1bf623ef1,0xbf753e953f753e95
.quad 0xbf6d3ec43f6d3ec4,0x3f6dbec4bf6dbec4,0x3e95bf75be95bf75,0xbf623ef13f623ef1,0x3f0e3f55bf0e3f55,0x3f55bf0ebf55bf0e,0xbf7fbdc93f7fbdc9,0xbf463f223f463f22
.quad 0x3f35bf35bf35bf35,0x3f35bf35bf35bf35,0x3dc93f7fbdc93f7f,0xbf223f463f223f46,0xbf55bf0e3f55bf0e,0x3f0ebf55bf0ebf55,0x3f75be95bf75be95,0xbef13f623ef13f62
.quad 0xbec43f6d3ec43f6d,0x3ec4bf6dbec4bf6d,0xbef1bf623ef1bf62,0xbe953f753e953f75,0x3f7b3e48bf7b3e48,0x3e48bf7bbe48bf7b,0xbf463f223f463f22,0xbdc93f7f3dc93f7f
.quad 0x3f800000bf003f00,0x3ec4bf6d3ec43f6d,0xbf800000bf003f00,0x3f6dbec43f6d3ec4,0x3f800000bf003f00,0x3f6d3ec43f6dbec4,0xbf800000bf003f00,0x3ec43f6d3ec4bf6d
.quad 0x3f800000bf003f00,0xbec43f6dbec4bf6d,0xbf800000bf003f00,0xbf6d3ec4bf6dbec4,0x3f800000bf003f00,0xbf6dbec4bf6d3ec4,0xbf800000bf003f00,0xbec4bf6dbec43f6d
.quad 0x3f800000bf003f00,0x3ec4bf6d3ec43f6d,0xbf800000bf003f00,0x3f6dbec43f6d3ec4,0x3f800000bf003f00,0x3f6d3ec43f6dbec4,0xbf800000bf003f00,0x3ec43f6d3ec4bf6d
.quad 0x3f800000bf003f00,0xbec43f6dbec4bf6d,0xbf800000bf003f00,0xbf6d3ec4bf6dbec4,0x3f800000bf003f00,0xbf6dbec4bf6d3ec4,0xbf800000bf003f00,0xbec4bf6dbec43f6d
.quad 0xbdc93f7fbdc9bf7f,0xbef13f62bef1bf62,0xbe953f75be95bf75,0xbf7f3dc9bf7fbdc9,0xbef13f62bef1bf62,0xbf22bf46bf223f46,0xbf223f46bf22bf46,0x3e95bf753e953f75
.quad 0xbf463f22bf46bf22,0x3f75be953f753e95,0xbf623ef1bf62bef1,0x3f463f223f46bf22,0xbf753e95bf75be95,0xbdc93f7fbdc9bf7f,0xbf7f3dc9bf7fbdc9,0xbf623ef1bf62bef1
.quad 0xbf7fbdc9bf7f3dc9,0xbf62bef1bf623ef1,0xbf75be95bf753e95,0xbdc9bf7fbdc93f7f,0xbf62bef1bf623ef1,0x3f46bf223f463f22,0xbf46bf22bf463f22,0x3f753e953f75be95
.quad 0xbf22bf46bf223f46,0x3e953f753e95bf75,0xbef1bf62bef13f62,0xbf223f46bf22bf46,0xbe95bf75be953f75,0xbf7fbdc9bf7f3dc9,0xbdc9bf7fbdc93f7f,0xbef1bf62bef13f62
.quad 0x3e48bf7b3e483f7b,0x3f0ebf553f0e3f55,0x3f0ebf553f0e3f55,0x3f7b3e483f7bbe48,0x3f55bf0e3f553f0e,0x3e483f7b3e48bf7b,0x3f7bbe483f7b3e48,0xbf553f0ebf55bf0e
.quad 0x3f7b3e483f7bbe48,0xbf55bf0ebf553f0e,0x3f553f0e3f55bf0e,0x3e48bf7b3e483f7b,0x3f0e3f553f0ebf55,0x3f7bbe483f7b3e48,0x3e483f7b3e48bf7b,0x3f0e3f553f0ebf55
.quad 0xbe483f7bbe48bf7b,0xbf0e3f55bf0ebf55,0xbf0e3f55bf0ebf55,0xbf7bbe48bf7b3e48,0xbf553f0ebf55bf0e,0xbe48bf7bbe483f7b,0xbf7b3e48bf7bbe48,0x3f55bf0e3f553f0e
.quad 0xbf7bbe48bf7b3e48,0x3f553f0e3f55bf0e,0xbf55bf0ebf553f0e,0xbe483f7bbe48bf7b,0xbf0ebf55bf0e3f55,0xbf7b3e48bf7bbe48,0xbe48bf7bbe483f7b,0xbf0ebf55bf0e3f55
.quad 0xbe953f75be95bf75,0xbf223f46bf22bf46,0xbf463f22bf46bf22,0xbf62bef1bf623ef1,0xbf7f3dc9bf7fbdc9,0x3e95bf753e953f75,0xbf62bef1bf623ef1,0x3f7f3dc93f7fbdc9
.quad 0xbef1bf62bef13f62,0x3dc93f7f3dc9bf7f,0x3dc9bf7f3dc93f7f,0xbf753e95bf75be95,0x3f22bf463f223f46,0xbef1bf62bef13f62,0x3f75be953f753e95,0x3f46bf223f463f22
.quad 0x3f753e953f75be95,0x3f463f223f46bf22,0x3f223f463f22bf46,0xbef13f62bef1bf62,0x3dc93f7f3dc9bf7f,0xbf75be95bf753e95,0xbef13f62bef1bf62,0x3dc9bf7f3dc93f7f
.quad 0xbf623ef1bf62bef1,0x3f7fbdc93f7f3dc9,0xbf7fbdc9bf7f3dc9,0x3e953f753e95bf75,0xbf46bf22bf463f22,0xbf623ef1bf62bef1,0xbe95bf75be953f75,0xbf22bf46bf223f46
.quad 0x3f35bf353f353f35,0x3f6dbec43f6d3ec4,0x3f353f353f35bf35,0xbec43f6dbec4bf6d,0xbf353f35bf35bf35,0xbec4bf6dbec43f6d,0xbf35bf35bf353f35,0x3f6d3ec43f6dbec4
.quad 0x3f35bf353f353f35,0xbf6d3ec4bf6dbec4,0x3f353f353f35bf35,0x3ec4bf6d3ec43f6d,0xbf353f35bf35bf35,0x3ec43f6d3ec4bf6d,0xbf35bf35bf353f35,0xbf6dbec4bf6d3ec4
.quad 0x3f35bf353f353f35,0x3f6dbec43f6d3ec4,0x3f353f353f35bf35,0xbec43f6dbec4bf6d,0xbf353f35bf35bf35,0xbec4bf6dbec43f6d,0xbf35bf35bf353f35,0x3f6d3ec43f6dbec4
.quad 0x3f35bf353f353f35,0xbf6d3ec4bf6dbec4,0x3f353f353f35bf35,0x3ec4bf6d3ec43f6d,0xbf353f35bf35bf35,0x3ec43f6d3ec4bf6d,0xbf35bf35bf353f35,0xbf6dbec4bf6d3ec4
.quad 0xbf463f22bf46bf22,0xbf753e95bf75be95,0xbef1bf62bef13f62,0x3f22bf463f223f46,0x3f75be953f753e95,0xbdc93f7fbdc9bf7f,0x3dc93f7f3dc9bf7f,0xbef1bf62bef13f62
.quad 0xbf7fbdc9bf7f3dc9,0x3f623ef13f62bef1,0x3e95bf753e953f75,0xbf7f3dc9bf7fbdc9,0x3f623ef13f62bef1,0x3f46bf223f463f22,0xbf223f46bf22bf46,0xbe953f75be95bf75
.quad 0xbf22bf46bf223f46,0xbe95bf75be953f75,0x3f62bef13f623ef1,0x3f463f223f46bf22,0x3e953f753e95bf75,0xbf7fbdc9bf7f3dc9,0xbf7f3dc9bf7fbdc9,0x3f62bef13f623ef1
.quad 0x3dc9bf7f3dc93f7f,0xbef13f62bef1bf62,0x3f753e953f75be95,0xbdc9bf7fbdc93f7f,0xbef13f62bef1bf62,0x3f223f463f22bf46,0xbf46bf22bf463f22,0xbf75be95bf753e95
.quad 0x3f55bf0e3f553f0e,0x3f7bbe483f7b3e48,0x3e483f7b3e48bf7b,0xbf553f0ebf55bf0e,0xbf7bbe48bf7b3e48,0x3f0ebf553f0e3f55,0x3f0ebf553f0e3f55,0xbe483f7bbe48bf7b
.quad 0x3f0e3f553f0ebf55,0xbe48bf7bbe483f7b,0xbf7b3e48bf7bbe48,0x3f0e3f553f0ebf55,0x3e48bf7b3e483f7b,0xbf55bf0ebf553f0e,0x3f553f0e3f55bf0e,0x3f7b3e483f7bbe48
.quad 0xbf553f0ebf55bf0e,0xbf7b3e48bf7bbe48,0xbe48bf7bbe483f7b,0x3f55bf0e3f553f0e,0x3f7b3e483f7bbe48,0xbf0e3f55bf0ebf55,0xbf0e3f55bf0ebf55,0x3e48bf7b3e483f7b
.quad 0xbf0ebf55bf0e3f55,0x3e483f7b3e48bf7b,0x3f7bbe483f7b3e48,0xbf0ebf55bf0e3f55,0xbe483f7bbe48bf7b,0x3f553f0e3f55bf0e,0xbf55bf0ebf553f0e,0xbf7bbe48bf7b3e48
.quad 0xbf623ef1bf62bef1,0xbf7f3dc9bf7fbdc9,0x3dc9bf7f3dc93f7f,0x3f75be953f753e95,0x3f463f223f46bf22,0xbf623ef1bf62bef1,0xbf753e95bf75be95,0x3f46bf223f463f22
.quad 0x3e95bf753e953f75,0xbf223f46bf22bf46,0x3f223f463f22bf46,0x3ef1bf623ef13f62,0xbf7f3dc9bf7fbdc9,0xbe953f75be95bf75,0x3ef1bf623ef13f62,0x3dc9bf7f3dc93f7f
.quad 0x3ef13f623ef1bf62,0x3dc93f7f3dc9bf7f,0xbf7fbdc9bf7f3dc9,0xbe95bf75be953f75,0x3f22bf463f223f46,0x3ef13f623ef1bf62,0x3e953f753e95bf75,0xbf22bf46bf223f46
.quad 0xbf75be95bf753e95,0x3f463f223f46bf22,0x3f46bf223f463f22,0xbf62bef1bf623ef1,0x3dc93f7f3dc9bf7f,0x3f753e953f75be95,0xbf62bef1bf623ef1,0xbf7fbdc9bf7f3dc9
.quad 0x3f803d493f80bd49,0x3f673edb3f67bedb,0x3f7d3e163f7dbe16,0x3e793f783e79bf78,0x3f783e793f78be79,0xbf183f4ebf18bf4e,0x3f713eac3f71beac,0xbf803d49bf80bd49
.quad 0x3f673edb3f67bedb,0xbf2cbf3ebf2c3f3e,0x3f5c3f043f5cbf04,0x3e16bf7d3e163f7d,0x3f4e3f183f4ebf18,0x3f5cbf043f5c3f04,0x3f3e3f2c3f3ebf2c,0x3f713eac3f71beac
.quad 0x3f2c3f3e3f2cbf3e,0x3eac3f713eacbf71,0x3f183f4e3f18bf4e,0xbf043f5cbf04bf5c,0x3f043f5c3f04bf5c,0xbf7d3e16bf7dbe16,0x3edb3f673edbbf67,0xbf3ebf2cbf3e3f2c
.quad 0x3eac3f713eacbf71,0x3d49bf803d493f80,0x3e793f783e79bf78,0x3f4ebf183f4e3f18,0x3e163f7d3e16bf7d,0x3f783e793f78be79,0x3d493f803d49bf80,0x3edb3f673edbbf67
.quad 0xbf7dbe16bf7d3e16,0xbf5cbf04bf5c3f04,0xbf67bedbbf673edb,0x3d49bf803d493f80,0xbf3ebf2cbf3e3f2c,0x3f67bedb3f673edb,0xbf04bf5cbf043f5c,0x3f4e3f183f4ebf18
.quad 0xbe79bf78be793f78,0xbe163f7dbe16bf7d,0x3d49bf803d493f80,0xbf713eacbf71beac,0x3eacbf713eac3f71,0xbf3ebf2cbf3e3f2c,0x3f18bf4e3f183f4e,0x3e79bf783e793f78
.quad 0x3f4ebf183f4e3f18,0x3f78be793f783e79,0x3f71beac3f713eac,0x3f2c3f3e3f2cbf3e,0x3f80bd493f803d49,0xbeac3f71beacbf71,0x3f783e793f78be79,0xbf7d3e16bf7dbe16
.quad 0x3f5c3f043f5cbf04,0xbf18bf4ebf183f4e,0x3f2c3f3e3f2cbf3e,0x3edbbf673edb3f67,0x3edb3f673edbbf67,0x3f80bd493f803d49,0x3e163f7d3e16bf7d,0x3f043f5c3f04bf5c
.quad 0x3f783e793f78be79,0x3f4e3f183f4ebf18,0x3f3e3f2c3f3ebf2c,0xbeac3f71beacbf71,0x3eac3f713eacbf71,0xbf80bd49bf803d49,0xbe163f7dbe16bf7d,0xbe79bf78be793f78
.quad 0xbf183f4ebf18bf4e,0x3f5cbf043f5c3f04,0xbf673edbbf67bedb,0x3f3e3f2c3f3ebf2c,0xbf80bd49bf803d49,0xbedb3f67bedbbf67,0xbf5cbf04bf5c3f04,0xbf7dbe16bf7d3e16
.quad 0xbf04bf5cbf043f5c,0xbe16bf7dbe163f7d,0xbd49bf80bd493f80,0x3f67bedb3f673edb,0x3edbbf673edb3f67,0x3f2c3f3e3f2cbf3e,0x3f4ebf183f4e3f18,0xbf043f5cbf04bf5c
.quad 0x3f7dbe163f7d3e16,0xbf78be79bf783e79,0x3f713eac3f71beac,0xbd49bf80bd493f80,0x3f2c3f3e3f2cbf3e,0x3f71beac3f713eac,0x3e793f783e79bf78,0x3f183f4e3f18bf4e
.quad 0xbf71beacbf713eac,0xbf3ebf2cbf3e3f2c,0xbf04bf5cbf043f5c,0x3f18bf4e3f183f4e,0x3e16bf7d3e163f7d,0x3f5c3f043f5cbf04,0x3f3ebf2c3f3e3f2c,0xbedb3f67bedbbf67
.quad 0x3f80bd493f803d49,0xbf71beacbf713eac,0x3f4e3f183f4ebf18,0x3e79bf783e793f78,0x3e793f783e79bf78,0x3f7d3e163f7dbe16,0xbedb3f67bedbbf67,0xbd493f80bd49bf80
.quad 0xbf673edbbf67bedb,0xbf803d49bf80bd49,0xbf78be79bf783e79,0xbe16bf7dbe163f7d,0xbf18bf4ebf183f4e,0x3f78be793f783e79,0x3d49bf803d493f80,0x3eac3f713eacbf71
.quad 0x3f2cbf3e3f2c3f3e,0xbf673edbbf67bedb,0x3f7dbe163f7d3e16,0xbf04bf5cbf043f5c,0x3f5c3f043f5cbf04,0x3f4ebf183f4e3f18,0x3eac3f713eacbf71,0x3f2c3f3e3f2cbf3e
.quad 0x3f2c3f3e3f2cbf3e,0x3eac3f713eacbf71,0xbf4e3f18bf4ebf18,0xbf5cbf04bf5c3f04,0xbf04bf5cbf043f5c,0x3f7dbe163f7d3e16,0x3f67bedb3f673edb,0xbf2c3f3ebf2cbf3e
.quad 0x3eac3f713eacbf71,0x3d49bf803d493f80,0xbf783e79bf78be79,0x3f183f4e3f18bf4e,0xbe16bf7dbe163f7d,0xbf78be79bf783e79,0x3f80bd493f803d49,0x3f67bedb3f673edb
.quad 0xbd493f80bd49bf80,0xbedb3f67bedbbf67,0xbf7dbe16bf7d3e16,0xbe79bf78be793f78,0x3e79bf783e793f78,0x3f4e3f183f4ebf18,0x3f713eac3f71beac,0xbf803d49bf80bd49
.quad 0xbedb3f67bedbbf67,0x3f3ebf2c3f3e3f2c,0xbf5cbf04bf5c3f04,0xbe163f7dbe16bf7d,0x3f18bf4e3f183f4e,0xbf04bf5cbf043f5c,0x3f3e3f2c3f3ebf2c,0x3f713eac3f71beac
.quad 0xbf18bf4ebf183f4e,0xbe79bf78be793f78,0x3f71beac3f713eac,0x3f2c3f3e3f2cbf3e,0x3d493f803d49bf80,0xbf71beacbf713eac,0xbf78be79bf783e79,0x3f7dbe163f7d3e16
.quad 0x3f04bf5c3f043f5c,0xbf4e3f18bf4ebf18,0x3f2c3f3e3f2cbf3e,0x3edbbf673edb3f67,0xbf673edbbf67bedb,0x3d493f803d49bf80,0xbe16bf7dbe163f7d,0xbf04bf5cbf043f5c
.quad 0x3f7d3e163f7dbe16,0x3f5c3f043f5cbf04,0xbedb3f67bedbbf67,0xbf80bd49bf803d49,0xbf3ebf2cbf3e3f2c,0x3f67bedb3f673edb,0x3f5cbf043f5c3f04,0xbf183f4ebf18bf4e
.quad 0x3e793f783e79bf78,0x3e16bf7d3e163f7d,0xbf80bd49bf803d49,0x3eac3f713eacbf71,0x3eacbf713eac3f71,0xbf3ebf2cbf3e3f2c,0x3f4e3f183f4ebf18,0x3f783e793f78be79
.quad 0x3f043f5c3f04bf5c,0x3e163f7d3e16bf7d,0xbf803d49bf80bd49,0xbedbbf67bedb3f67,0x3edbbf673edb3f67,0x3f2c3f3e3f2cbf3e,0x3f183f4e3f18bf4e,0xbf5cbf04bf5c3f04
.quad 0xbf7d3e16bf7dbe16,0x3f783e793f78be79,0x3eacbf713eac3f71,0xbf803d49bf80bd49,0x3f2c3f3e3f2cbf3e,0x3f71beac3f713eac,0xbf783e79bf78be79,0xbf4e3f18bf4ebf18
.quad 0x3e79bf783e793f78,0x3f18bf4e3f183f4e,0x3f3e3f2c3f3ebf2c,0xbeac3f71beacbf71,0xbf713eacbf71beac,0x3d49bf803d493f80,0x3e16bf7d3e163f7d,0x3e793f783e79bf78
.quad 0x3f4e3f183f4ebf18,0xbf04bf5cbf043f5c,0xbf673edbbf67bedb,0x3f3e3f2c3f3ebf2c,0x3d49bf803d493f80,0xbf67bedbbf673edb,0x3f5c3f043f5cbf04,0x3f7d3e163f7dbe16
.quad 0xbedbbf67bedb3f67,0xbd49bf80bd493f80,0x3f783e793f78be79,0x3e163f7d3e16bf7d,0xbf4e3f18bf4ebf18,0xbe79bf78be793f78,0x3d49bf803d493f80,0x3eac3f713eacbf71
.quad 0x3f3e3f2c3f3ebf2c,0xbedbbf67bedb3f67,0xbf7d3e16bf7dbe16,0x3f043f5c3f04bf5c,0x3f04bf5c3f043f5c,0xbf18bf4ebf183f4e,0x3eac3f713eacbf71,0x3f2c3f3e3f2cbf3e
.quad 0xbf71beacbf713eac,0xbf3ebf2cbf3e3f2c,0x3f5cbf043f5c3f04,0x3f4e3f183f4ebf18,0xbe163f7dbe16bf7d,0xbf5cbf04bf5c3f04,0xbf2cbf3ebf2c3f3e,0x3f673edb3f67bedb
.quad 0x3f80bd493f803d49,0xbf71beacbf713eac,0xbf183f4ebf18bf4e,0x3f783e793f78be79,0xbe79bf78be793f78,0xbf7dbe16bf7d3e16,0x3f673edb3f67bedb,0x3f803d493f80bd49
.size k2_tbl, 16384
CODE_END:
.section .rodata,"a"
.p2align 6
.amdhsa_kernel k01_kernel
  .amdhsa_next_free_vgpr 253
  .amdhsa_next_free_sgpr 91
  .amdhsa_accum_offset 256
  .amdhsa_group_segment_fixed_size 0
  .amdhsa_kernarg_size 96
  .amdhsa_user_sgpr_count 2
  .amdhsa_user_sgpr_kernarg_segment_ptr 1
  .amdhsa_system_sgpr_workgroup_id_x 1
  .amdhsa_float_denorm_mode_32 3
.end_amdhsa_kernel
.p2align 6
.amdhsa_kernel k2_kernel
  .amdhsa_next_free_vgpr 512
  .amdhsa_next_free_sgpr 80
  .amdhsa_accum_offset 256
  .amdhsa_group_segment_fixed_size 0
  .amdhsa_kernarg_size 96
  .amdhsa_user_sgpr_count 2
  .amdhsa_user_sgpr_kernarg_segment_ptr 1
  .amdhsa_system_sgpr_workgroup_id_x 1
  .amdhsa_float_denorm_mode_32 3
.end_amdhsa_kernel
```
